```python
import torch

def _softmax(x, axis=-1):
    return torch.softmax(x, dim=axis)

def _gelu(x):
    return torch.nn.functional.gelu(x, approximate='tanh')

def _silu(x):
    return torch.nn.functional.silu(x)

def _sigmoid(x):
    return torch.sigmoid(x)

def _layernorm(x, axis=-1, eps=1e-05):
    m = x.mean(dim=axis, keepdim=True)
    v = x.var(dim=axis, keepdim=True, unbiased=False)
    return (x - m) / torch.sqrt(v + eps)

def _scatter_add(tgt, idx, src, axis=0):
    return tgt.clone().index_add_(axis, idx, src)

def _segment_sum(src, seg, n):
    out = torch.zeros((n,) + src.shape[1:], dtype=src.dtype)
    return out.index_add_(0, seg, src)

def _pad(x, pw):
    flat = tuple((v for pair in reversed(pw) for v in pair))
    return torch.nn.functional.pad(x, flat)
kernel_name = 'gather_scatter__molecular_angular_painn__graph'

def setup_inputs():

    _w = lambda a: (lambda t: t.to(torch.bfloat16) if t.is_floating_point() else t)(torch.as_tensor(a))
    N, deg, D = (12500, 32, 128)
    n_rbf = max(4, 4)
    E = N * deg
    cutoff = 5.0
    freqs = (torch.arange(1, n_rbf + 1) * torch.pi / cutoff).to(float)
    return {'sv': _w((lambda *s: torch.randn(*s, dtype=torch.bfloat16) * 0.4)(N, 4, D) * 0.3), 'pos': _w((lambda *s: torch.randn(*s, dtype=torch.bfloat16) * 3.2)(N, 3) * 1.2), 'src': _w((lambda lo, hi, *s: torch.randint(lo, hi, s))(0, N, E).to(torch.int64)), 'dst': _w((lambda lo, hi, *s: torch.randint(lo, hi, s))(0, N, E).to(torch.int64)), 'freqs': _w(freqs), 'w_phi1': _w((lambda *s: torch.randn(*s, dtype=torch.bfloat16) * 3.2)(D, D) / D ** 0.5), 'w_phi2': _w((lambda *s: torch.randn(*s, dtype=torch.bfloat16) * 3.2)(D, 3 * D) / D ** 0.5), 'w_rbf': _w((lambda *s: torch.randn(*s, dtype=torch.bfloat16) * 3.2)(n_rbf, 3 * D) / n_rbf ** 0.5)}

def reference(sv, pos, src, dst, freqs, w_phi1, w_phi2, w_rbf):
    N, _, D = sv.shape
    E = src.shape[0]
    PI, cutoff = (3.141592653589793, 5.0)
    s, v = (sv[:, 0, :].clone(), sv[:, 1:, :].clone())
    r_vec = pos[src] - pos[dst]
    d = torch.sqrt((r_vec * r_vec).sum(-1) + 1e-08)
    r_hat = r_vec / d[:, None]
    rbf = torch.sin(d[:, None] * freqs[None, :]) / d[:, None]
    fcut = 0.5 * (torch.cos(PI * d / cutoff) + 1.0)
    fcut = torch.where(d < cutoff, fcut, 0.0 * d)
    Wf = rbf @ w_rbf * fcut[:, None]
    phi = (_silu(s @ w_phi1) @ w_phi2)[src]
    m = phi * Wf
    m_s, m_vv, m_vr = (m[:, :D].clone(), m[:, D:2 * D].clone(), m[:, 2 * D:].clone())
    ds = _segment_sum(m_s, dst, N)
    dv_e = m_vv[:, None, :] * v[src] + m_vr[:, None, :] * r_hat[:, :, None]
    dv = _segment_sum(dv_e.reshape(E, 3 * D), dst, N).reshape(N, 3, D)
    return sv + torch.concatenate([ds[:, None, :], dv], axis=1)
```

```asm
; @launch kernel=painn_prep_kernel grid=(256,1,1) block=(512,1,1) lds=153600
; @launch kernel=painn_main_kernel grid=(3128,1,1) block=(64,1,1) lds=4608
.amdgcn_target "amdgcn-amd-amdhsa--gfx950"
.text
.globl painn_prep_kernel
.p2align 8
.type painn_prep_kernel,@function
painn_prep_kernel:
    s_cmp_ge_u32 s2, 32
    s_cbranch_scc1 K1_NOPF
    s_getpc_b64 s[94:95]
K1_PC:
    v_lshlrev_b32 v250, 6, v0
    v_cmp_gt_u32 vcc, K2_END-K1_PC, v250
    s_and_saveexec_b64 s[92:93], vcc
    s_cbranch_execz K1_PFX
    global_load_dword v251, v250, s[94:95]
K1_PFX:
    s_mov_b64 exec, s[92:93]
K1_NOPF:
    s_cmp_ge_u32 s2, 256
    s_cbranch_scc1 K1_END
    s_cmp_ge_u32 s2, 60
    s_cbranch_scc1 K1_GEMM
    s_load_dwordx4 s[4:7], s[0:1], 8
    s_load_dwordx4 s[8:11], s[0:1], 24
    s_load_dwordx2 s[12:13], s[0:1], 80
    v_lshrrev_b32 v1, 6, v0
    v_and_b32 v2, 63, v0
    v_readfirstlane_b32 s3, v1
    v_lshlrev_b32 v3, 4, v0
    v_mul_u32_u24 v4, 12, v0
    s_waitcnt lgkmcnt(0)
    s_load_dwordx2 s[36:37], s[10:11], 0
    s_mov_b32 s16, s4
    s_mov_b32 s17, s5
    s_mov_b32 s18, 75000
    s_mov_b32 s19, 0x00020000
    s_mov_b32 s20, s6
    s_mov_b32 s21, s7
    s_mov_b32 s22, 1600000
    s_mov_b32 s23, 0x00020000
    s_mov_b32 s24, s8
    s_mov_b32 s25, s9
    s_mov_b32 s26, 1600000
    s_mov_b32 s27, 0x00020000
    s_add_u32 s28, s12, 0x1000000
    s_addc_u32 s29, s13, 0
    s_mov_b32 s30, 6405120
    s_mov_b32 s31, 0x00020000
    s_add_u32 s32, s12, 0x2000000
    s_addc_u32 s33, s13, 0
    s_mov_b32 s34, 401408
    s_mov_b32 s35, 0x00020000
    s_mul_i32 s42, s2, 6672
    s_sub_u32 s43, 400000, s42
    s_min_u32 s43, s43, 6672
    s_lshl_b32 s44, s42, 2
    s_add_u32 s45, s44, 0
    buffer_load_dwordx4 v[8:11], v3, s[20:23], s45 offen nt
    buffer_load_dwordx4 v[24:27], v3, s[24:27], s45 offen nt
    s_add_u32 s45, s44, 8192
    buffer_load_dwordx4 v[12:15], v3, s[20:23], s45 offen nt
    buffer_load_dwordx4 v[28:31], v3, s[24:27], s45 offen nt
    s_add_u32 s45, s44, 16384
    buffer_load_dwordx4 v[16:19], v3, s[20:23], s45 offen nt
    buffer_load_dwordx4 v[32:35], v3, s[24:27], s45 offen nt
    v_lshlrev_b32 v47, 2, v0
    s_add_u32 s45, s44, 24576
    buffer_load_dword v20, v47, s[20:23], s45 offen offset:0 nt
    buffer_load_dword v36, v47, s[24:27], s45 offen offset:0 nt
    buffer_load_dword v21, v47, s[20:23], s45 offen offset:2048 nt
    buffer_load_dword v37, v47, s[24:27], s45 offen offset:2048 nt
    s_mov_b32 s45, 0
    buffer_load_dwordx3 v[128:130], v4, s[16:19], s45 offen
    s_mov_b32 s45, 6144
    buffer_load_dwordx3 v[132:134], v4, s[16:19], s45 offen
    s_mov_b32 s45, 12288
    buffer_load_dwordx3 v[136:138], v4, s[16:19], s45 offen
    s_mov_b32 s45, 18432
    buffer_load_dwordx3 v[140:142], v4, s[16:19], s45 offen
    s_mov_b32 s45, 24576
    buffer_load_dwordx3 v[144:146], v4, s[16:19], s45 offen
    s_mov_b32 s45, 30720
    buffer_load_dwordx3 v[148:150], v4, s[16:19], s45 offen
    s_mov_b32 s45, 36864
    buffer_load_dwordx3 v[152:154], v4, s[16:19], s45 offen
    s_mov_b32 s45, 43008
    buffer_load_dwordx3 v[156:158], v4, s[16:19], s45 offen
    s_mov_b32 s45, 49152
    buffer_load_dwordx3 v[160:162], v4, s[16:19], s45 offen
    s_mov_b32 s45, 55296
    buffer_load_dwordx3 v[164:166], v4, s[16:19], s45 offen
    s_mov_b32 s45, 61440
    buffer_load_dwordx3 v[168:170], v4, s[16:19], s45 offen
    s_mov_b32 s45, 67584
    buffer_load_dwordx3 v[172:174], v4, s[16:19], s45 offen
    s_mov_b32 s45, 73728
    buffer_load_dwordx3 v[176:178], v4, s[16:19], s45 offen
    v_mov_b32 v40, 0
    v_mov_b32 v41, 0
    v_mov_b32 v42, 0
    v_mov_b32 v43, 0
    v_add_u32 v5, 100096, v3
    v_cmp_gt_u32 vcc, 392, v0
    s_and_saveexec_b64 s[46:47], vcc
    ds_write_b128 v5, v[40:43]
    s_mov_b64 exec, s[46:47]
    v_mov_b32 v6, 146400
    v_cmp_eq_u32 vcc, 0, v0
    s_and_saveexec_b64 s[46:47], vcc
    ds_write_b32 v6, v40
    s_mov_b64 exec, s[46:47]
    v_add_u32 v45, 0x10000, v3
    s_waitcnt vmcnt(12)
    v_and_b32 v131, 0xffff0000, v130
    v_alignbit_b32 v130, v130, v129, 16
    v_lshlrev_b32 v129, 16, v129
    ds_write_b128 v3, v[128:131] offset:0
    s_waitcnt vmcnt(11)
    v_and_b32 v135, 0xffff0000, v134
    v_alignbit_b32 v134, v134, v133, 16
    v_lshlrev_b32 v133, 16, v133
    ds_write_b128 v3, v[132:135] offset:8192
    s_waitcnt vmcnt(10)
    v_and_b32 v139, 0xffff0000, v138
    v_alignbit_b32 v138, v138, v137, 16
    v_lshlrev_b32 v137, 16, v137
    ds_write_b128 v3, v[136:139] offset:16384
    s_waitcnt vmcnt(9)
    v_and_b32 v143, 0xffff0000, v142
    v_alignbit_b32 v142, v142, v141, 16
    v_lshlrev_b32 v141, 16, v141
    ds_write_b128 v3, v[140:143] offset:24576
    s_waitcnt vmcnt(8)
    v_and_b32 v147, 0xffff0000, v146
    v_alignbit_b32 v146, v146, v145, 16
    v_lshlrev_b32 v145, 16, v145
    ds_write_b128 v3, v[144:147] offset:32768
    s_waitcnt vmcnt(7)
    v_and_b32 v151, 0xffff0000, v150
    v_alignbit_b32 v150, v150, v149, 16
    v_lshlrev_b32 v149, 16, v149
    ds_write_b128 v3, v[148:151] offset:40960
    s_waitcnt vmcnt(6)
    v_and_b32 v155, 0xffff0000, v154
    v_alignbit_b32 v154, v154, v153, 16
    v_lshlrev_b32 v153, 16, v153
    ds_write_b128 v3, v[152:155] offset:49152
    s_waitcnt vmcnt(5)
    v_and_b32 v159, 0xffff0000, v158
    v_alignbit_b32 v158, v158, v157, 16
    v_lshlrev_b32 v157, 16, v157
    ds_write_b128 v3, v[156:159] offset:57344
    s_waitcnt vmcnt(4)
    v_and_b32 v163, 0xffff0000, v162
    v_alignbit_b32 v162, v162, v161, 16
    v_lshlrev_b32 v161, 16, v161
    ds_write_b128 v45, v[160:163] offset:0
    s_waitcnt vmcnt(3)
    v_and_b32 v167, 0xffff0000, v166
    v_alignbit_b32 v166, v166, v165, 16
    v_lshlrev_b32 v165, 16, v165
    ds_write_b128 v45, v[164:167] offset:8192
    s_waitcnt vmcnt(2)
    v_and_b32 v171, 0xffff0000, v170
    v_alignbit_b32 v170, v170, v169, 16
    v_lshlrev_b32 v169, 16, v169
    ds_write_b128 v45, v[168:171] offset:16384
    s_waitcnt vmcnt(1)
    v_and_b32 v175, 0xffff0000, v174
    v_alignbit_b32 v174, v174, v173, 16
    v_lshlrev_b32 v173, 16, v173
    ds_write_b128 v45, v[172:175] offset:24576
    s_waitcnt vmcnt(0)
    v_and_b32 v179, 0xffff0000, v178
    v_alignbit_b32 v178, v178, v177, 16
    v_lshlrev_b32 v177, 16, v177
    v_cmp_gt_u32 vcc, 106, v0
    s_and_saveexec_b64 s[46:47], vcc
    ds_write_b128 v45, v[176:179] offset:32768
    s_mov_b64 exec, s[46:47]
    s_waitcnt vmcnt(0) lgkmcnt(0)
    s_barrier
    s_lshl_b32 s38, s36, 16
    s_and_b32 s39, s36, 0xffff0000
    s_lshl_b32 s40, s37, 16
    s_and_b32 s41, s37, 0xffff0000
    v_mov_b32 v7, 0x41c20000
    v_lshlrev_b32 v5, 2, v0
    v_mov_b32 v44, 1
    s_mov_b64 s[74:75], 0
    v_lshlrev_b32 v80, 3, v8
    v_lshlrev_b32 v81, 3, v24
    ds_read_b64 v[100:101], v80
    ds_read_b64 v[102:103], v81
    v_lshlrev_b32 v82, 3, v9
    v_lshlrev_b32 v83, 3, v25
    ds_read_b64 v[104:105], v82
    ds_read_b64 v[106:107], v83
    v_lshlrev_b32 v84, 3, v10
    v_lshlrev_b32 v85, 3, v26
    ds_read_b64 v[108:109], v84
    ds_read_b64 v[110:111], v85
    v_lshlrev_b32 v86, 3, v11
    v_lshlrev_b32 v87, 3, v27
    ds_read_b64 v[112:113], v86
    ds_read_b64 v[114:115], v87
    v_lshrrev_b32 v123, 1, v24
    v_and_b32 v123, -4, v123
    v_add_u32 v123, 100096, v123
    v_lshl_or_b32 v8, v24, 16, v8
    s_waitcnt lgkmcnt(6)
    v_lshlrev_b32 v120, 16, v100
    v_lshlrev_b32 v121, 16, v102
    v_and_b32 v100, 0xffff0000, v100
    v_and_b32 v102, 0xffff0000, v102
    v_sub_f32 v101, v101, v103
    v_sub_f32 v120, v120, v121
    v_sub_f32 v100, v100, v102
    v_mul_f32 v101, v101, v101
    v_fmac_f32 v101, v120, v120
    v_fmac_f32 v101, v100, v100
    v_cmp_lt_f32 s[48:49], v101, v7
    s_nop 0
    s_mov_b64 exec, s[48:49]
    ds_add_rtn_u32 v64, v123, v44
    s_mov_b64 exec, -1
    v_lshrrev_b32 v123, 1, v25
    v_and_b32 v123, -4, v123
    v_add_u32 v123, 100096, v123
    v_lshl_or_b32 v9, v25, 16, v9
    s_waitcnt lgkmcnt(4)
    v_lshlrev_b32 v120, 16, v104
    v_lshlrev_b32 v121, 16, v106
    v_and_b32 v104, 0xffff0000, v104
    v_and_b32 v106, 0xffff0000, v106
    v_sub_f32 v105, v105, v107
    v_sub_f32 v120, v120, v121
    v_sub_f32 v104, v104, v106
    v_mul_f32 v105, v105, v105
    v_fmac_f32 v105, v120, v120
    v_fmac_f32 v105, v104, v104
    v_cmp_lt_f32 s[50:51], v105, v7
    s_nop 0
    s_mov_b64 exec, s[50:51]
    ds_add_rtn_u32 v65, v123, v44
    s_mov_b64 exec, -1
    v_lshrrev_b32 v123, 1, v26
    v_and_b32 v123, -4, v123
    v_add_u32 v123, 100096, v123
    v_lshl_or_b32 v10, v26, 16, v10
    s_waitcnt lgkmcnt(2)
    v_lshlrev_b32 v120, 16, v108
    v_lshlrev_b32 v121, 16, v110
    v_and_b32 v108, 0xffff0000, v108
    v_and_b32 v110, 0xffff0000, v110
    v_sub_f32 v109, v109, v111
    v_sub_f32 v120, v120, v121
    v_sub_f32 v108, v108, v110
    v_mul_f32 v109, v109, v109
    v_fmac_f32 v109, v120, v120
    v_fmac_f32 v109, v108, v108
    v_cmp_lt_f32 s[52:53], v109, v7
    s_nop 0
    s_mov_b64 exec, s[52:53]
    ds_add_rtn_u32 v66, v123, v44
    s_mov_b64 exec, -1
    v_lshrrev_b32 v123, 1, v27
    v_and_b32 v123, -4, v123
    v_add_u32 v123, 100096, v123
    v_lshl_or_b32 v11, v27, 16, v11
    s_waitcnt lgkmcnt(0)
    v_lshlrev_b32 v120, 16, v112
    v_lshlrev_b32 v121, 16, v114
    v_and_b32 v112, 0xffff0000, v112
    v_and_b32 v114, 0xffff0000, v114
    v_sub_f32 v113, v113, v115
    v_sub_f32 v120, v120, v121
    v_sub_f32 v112, v112, v114
    v_mul_f32 v113, v113, v113
    v_fmac_f32 v113, v120, v120
    v_fmac_f32 v113, v112, v112
    v_cmp_lt_f32 s[54:55], v113, v7
    s_nop 0
    s_mov_b64 exec, s[54:55]
    ds_add_rtn_u32 v67, v123, v44
    s_mov_b64 exec, -1
    v_lshlrev_b32 v80, 3, v12
    v_lshlrev_b32 v81, 3, v28
    ds_read_b64 v[100:101], v80
    ds_read_b64 v[102:103], v81
    v_lshlrev_b32 v82, 3, v13
    v_lshlrev_b32 v83, 3, v29
    ds_read_b64 v[104:105], v82
    ds_read_b64 v[106:107], v83
    v_lshlrev_b32 v84, 3, v14
    v_lshlrev_b32 v85, 3, v30
    ds_read_b64 v[108:109], v84
    ds_read_b64 v[110:111], v85
    v_lshlrev_b32 v86, 3, v15
    v_lshlrev_b32 v87, 3, v31
    ds_read_b64 v[112:113], v86
    ds_read_b64 v[114:115], v87
    v_lshrrev_b32 v123, 1, v28
    v_and_b32 v123, -4, v123
    v_add_u32 v123, 100096, v123
    v_lshl_or_b32 v12, v28, 16, v12
    s_waitcnt lgkmcnt(6)
    v_lshlrev_b32 v120, 16, v100
    v_lshlrev_b32 v121, 16, v102
    v_and_b32 v100, 0xffff0000, v100
    v_and_b32 v102, 0xffff0000, v102
    v_sub_f32 v101, v101, v103
    v_sub_f32 v120, v120, v121
    v_sub_f32 v100, v100, v102
    v_mul_f32 v101, v101, v101
    v_fmac_f32 v101, v120, v120
    v_fmac_f32 v101, v100, v100
    v_cmp_lt_f32 s[56:57], v101, v7
    s_nop 0
    s_mov_b64 exec, s[56:57]
    ds_add_rtn_u32 v68, v123, v44
    s_mov_b64 exec, -1
    v_lshrrev_b32 v123, 1, v29
    v_and_b32 v123, -4, v123
    v_add_u32 v123, 100096, v123
    v_lshl_or_b32 v13, v29, 16, v13
    s_waitcnt lgkmcnt(4)
    v_lshlrev_b32 v120, 16, v104
    v_lshlrev_b32 v121, 16, v106
    v_and_b32 v104, 0xffff0000, v104
    v_and_b32 v106, 0xffff0000, v106
    v_sub_f32 v105, v105, v107
    v_sub_f32 v120, v120, v121
    v_sub_f32 v104, v104, v106
    v_mul_f32 v105, v105, v105
    v_fmac_f32 v105, v120, v120
    v_fmac_f32 v105, v104, v104
    v_cmp_lt_f32 s[58:59], v105, v7
    s_nop 0
    s_mov_b64 exec, s[58:59]
    ds_add_rtn_u32 v69, v123, v44
    s_mov_b64 exec, -1
    v_lshrrev_b32 v123, 1, v30
    v_and_b32 v123, -4, v123
    v_add_u32 v123, 100096, v123
    v_lshl_or_b32 v14, v30, 16, v14
    s_waitcnt lgkmcnt(2)
    v_lshlrev_b32 v120, 16, v108
    v_lshlrev_b32 v121, 16, v110
    v_and_b32 v108, 0xffff0000, v108
    v_and_b32 v110, 0xffff0000, v110
    v_sub_f32 v109, v109, v111
    v_sub_f32 v120, v120, v121
    v_sub_f32 v108, v108, v110
    v_mul_f32 v109, v109, v109
    v_fmac_f32 v109, v120, v120
    v_fmac_f32 v109, v108, v108
    v_cmp_lt_f32 s[60:61], v109, v7
    s_nop 0
    s_mov_b64 exec, s[60:61]
    ds_add_rtn_u32 v70, v123, v44
    s_mov_b64 exec, -1
    v_lshrrev_b32 v123, 1, v31
    v_and_b32 v123, -4, v123
    v_add_u32 v123, 100096, v123
    v_lshl_or_b32 v15, v31, 16, v15
    s_waitcnt lgkmcnt(0)
    v_lshlrev_b32 v120, 16, v112
    v_lshlrev_b32 v121, 16, v114
    v_and_b32 v112, 0xffff0000, v112
    v_and_b32 v114, 0xffff0000, v114
    v_sub_f32 v113, v113, v115
    v_sub_f32 v120, v120, v121
    v_sub_f32 v112, v112, v114
    v_mul_f32 v113, v113, v113
    v_fmac_f32 v113, v120, v120
    v_fmac_f32 v113, v112, v112
    v_cmp_lt_f32 s[62:63], v113, v7
    s_nop 0
    s_mov_b64 exec, s[62:63]
    ds_add_rtn_u32 v71, v123, v44
    s_mov_b64 exec, -1
    v_lshlrev_b32 v80, 3, v16
    v_lshlrev_b32 v81, 3, v32
    ds_read_b64 v[100:101], v80
    ds_read_b64 v[102:103], v81
    v_lshlrev_b32 v82, 3, v17
    v_lshlrev_b32 v83, 3, v33
    ds_read_b64 v[104:105], v82
    ds_read_b64 v[106:107], v83
    v_lshlrev_b32 v84, 3, v18
    v_lshlrev_b32 v85, 3, v34
    ds_read_b64 v[108:109], v84
    ds_read_b64 v[110:111], v85
    v_lshlrev_b32 v86, 3, v19
    v_lshlrev_b32 v87, 3, v35
    ds_read_b64 v[112:113], v86
    ds_read_b64 v[114:115], v87
    v_lshlrev_b32 v88, 3, v20
    v_lshlrev_b32 v89, 3, v36
    ds_read_b64 v[116:117], v88
    ds_read_b64 v[118:119], v89
    v_lshrrev_b32 v123, 1, v32
    v_and_b32 v123, -4, v123
    v_add_u32 v123, 100096, v123
    v_lshl_or_b32 v16, v32, 16, v16
    s_waitcnt lgkmcnt(8)
    v_lshlrev_b32 v120, 16, v100
    v_lshlrev_b32 v121, 16, v102
    v_and_b32 v100, 0xffff0000, v100
    v_and_b32 v102, 0xffff0000, v102
    v_sub_f32 v101, v101, v103
    v_sub_f32 v120, v120, v121
    v_sub_f32 v100, v100, v102
    v_mul_f32 v101, v101, v101
    v_fmac_f32 v101, v120, v120
    v_fmac_f32 v101, v100, v100
    v_cmp_lt_f32 s[64:65], v101, v7
    s_nop 0
    s_mov_b64 exec, s[64:65]
    ds_add_rtn_u32 v72, v123, v44
    s_mov_b64 exec, -1
    v_lshrrev_b32 v123, 1, v33
    v_and_b32 v123, -4, v123
    v_add_u32 v123, 100096, v123
    v_lshl_or_b32 v17, v33, 16, v17
    s_waitcnt lgkmcnt(6)
    v_lshlrev_b32 v120, 16, v104
    v_lshlrev_b32 v121, 16, v106
    v_and_b32 v104, 0xffff0000, v104
    v_and_b32 v106, 0xffff0000, v106
    v_sub_f32 v105, v105, v107
    v_sub_f32 v120, v120, v121
    v_sub_f32 v104, v104, v106
    v_mul_f32 v105, v105, v105
    v_fmac_f32 v105, v120, v120
    v_fmac_f32 v105, v104, v104
    v_cmp_lt_f32 s[66:67], v105, v7
    s_nop 0
    s_mov_b64 exec, s[66:67]
    ds_add_rtn_u32 v73, v123, v44
    s_mov_b64 exec, -1
    v_lshrrev_b32 v123, 1, v34
    v_and_b32 v123, -4, v123
    v_add_u32 v123, 100096, v123
    v_lshl_or_b32 v18, v34, 16, v18
    s_waitcnt lgkmcnt(4)
    v_lshlrev_b32 v120, 16, v108
    v_lshlrev_b32 v121, 16, v110
    v_and_b32 v108, 0xffff0000, v108
    v_and_b32 v110, 0xffff0000, v110
    v_sub_f32 v109, v109, v111
    v_sub_f32 v120, v120, v121
    v_sub_f32 v108, v108, v110
    v_mul_f32 v109, v109, v109
    v_fmac_f32 v109, v120, v120
    v_fmac_f32 v109, v108, v108
    v_cmp_lt_f32 s[68:69], v109, v7
    s_nop 0
    s_mov_b64 exec, s[68:69]
    ds_add_rtn_u32 v74, v123, v44
    s_mov_b64 exec, -1
    v_lshrrev_b32 v123, 1, v35
    v_and_b32 v123, -4, v123
    v_add_u32 v123, 100096, v123
    v_lshl_or_b32 v19, v35, 16, v19
    s_waitcnt lgkmcnt(2)
    v_lshlrev_b32 v120, 16, v112
    v_lshlrev_b32 v121, 16, v114
    v_and_b32 v112, 0xffff0000, v112
    v_and_b32 v114, 0xffff0000, v114
    v_sub_f32 v113, v113, v115
    v_sub_f32 v120, v120, v121
    v_sub_f32 v112, v112, v114
    v_mul_f32 v113, v113, v113
    v_fmac_f32 v113, v120, v120
    v_fmac_f32 v113, v112, v112
    v_cmp_lt_f32 s[70:71], v113, v7
    s_nop 0
    s_mov_b64 exec, s[70:71]
    ds_add_rtn_u32 v75, v123, v44
    s_mov_b64 exec, -1
    v_lshrrev_b32 v123, 1, v36
    v_and_b32 v123, -4, v123
    v_add_u32 v123, 100096, v123
    v_lshl_or_b32 v20, v36, 16, v20
    v_add_u32 v122, 6144, v0
    s_waitcnt lgkmcnt(0)
    v_lshlrev_b32 v120, 16, v116
    v_lshlrev_b32 v121, 16, v118
    v_and_b32 v116, 0xffff0000, v116
    v_and_b32 v118, 0xffff0000, v118
    v_sub_f32 v117, v117, v119
    v_sub_f32 v120, v120, v121
    v_sub_f32 v116, v116, v118
    v_mul_f32 v117, v117, v117
    v_fmac_f32 v117, v120, v120
    v_fmac_f32 v117, v116, v116
    v_cmp_gt_u32 s[46:47], s43, v122
    v_cmp_lt_f32 vcc, v117, v7
    s_nop 0
    s_and_b64 s[72:73], vcc, s[46:47]
    s_mov_b64 exec, s[72:73]
    ds_add_rtn_u32 v76, v123, v44
    s_mov_b64 exec, -1
    s_cmp_ge_u32 s3, 1
    s_cbranch_scc1 K1E_P1DONE
    v_lshlrev_b32 v80, 3, v21
    v_lshlrev_b32 v81, 3, v37
    ds_read_b64 v[100:101], v80
    ds_read_b64 v[102:103], v81
    v_lshrrev_b32 v123, 1, v37
    v_and_b32 v123, -4, v123
    v_add_u32 v123, 100096, v123
    v_lshl_or_b32 v21, v37, 16, v21
    v_add_u32 v122, 6656, v0
    s_waitcnt lgkmcnt(0)
    v_lshlrev_b32 v120, 16, v100
    v_lshlrev_b32 v121, 16, v102
    v_and_b32 v100, 0xffff0000, v100
    v_and_b32 v102, 0xffff0000, v102
    v_sub_f32 v101, v101, v103
    v_sub_f32 v120, v120, v121
    v_sub_f32 v100, v100, v102
    v_mul_f32 v101, v101, v101
    v_fmac_f32 v101, v120, v120
    v_fmac_f32 v101, v100, v100
    v_cmp_gt_u32 s[46:47], s43, v122
    v_cmp_lt_f32 vcc, v101, v7
    s_nop 0
    s_and_b64 s[74:75], vcc, s[46:47]
    s_mov_b64 exec, s[74:75]
    ds_add_rtn_u32 v77, v123, v44
    s_mov_b64 exec, -1
K1E_P1DONE:
    s_mov_b32 s45, 0
    s_bcnt1_i32_b64 s46, s[48:49]
    s_add_u32 s45, s45, s46
    s_bcnt1_i32_b64 s46, s[50:51]
    s_add_u32 s45, s45, s46
    s_bcnt1_i32_b64 s46, s[52:53]
    s_add_u32 s45, s45, s46
    s_bcnt1_i32_b64 s46, s[54:55]
    s_add_u32 s45, s45, s46
    s_bcnt1_i32_b64 s46, s[56:57]
    s_add_u32 s45, s45, s46
    s_bcnt1_i32_b64 s46, s[58:59]
    s_add_u32 s45, s45, s46
    s_bcnt1_i32_b64 s46, s[60:61]
    s_add_u32 s45, s45, s46
    s_bcnt1_i32_b64 s46, s[62:63]
    s_add_u32 s45, s45, s46
    s_bcnt1_i32_b64 s46, s[64:65]
    s_add_u32 s45, s45, s46
    s_bcnt1_i32_b64 s46, s[66:67]
    s_add_u32 s45, s45, s46
    s_bcnt1_i32_b64 s46, s[68:69]
    s_add_u32 s45, s45, s46
    s_bcnt1_i32_b64 s46, s[70:71]
    s_add_u32 s45, s45, s46
    s_bcnt1_i32_b64 s46, s[72:73]
    s_add_u32 s45, s45, s46
    s_bcnt1_i32_b64 s46, s[74:75]
    s_add_u32 s45, s45, s46
    v_mov_b32 v45, s45
    s_mov_b64 exec, 1
    ds_add_rtn_u32 v46, v6, v45
    s_mov_b64 exec, -1
    s_waitcnt lgkmcnt(0)
    v_readfirstlane_b32 s45, v46
    s_nop 1
    v_mov_b32 v124, s45
    v_mbcnt_lo_u32_b32 v124, s48, v124
    v_mbcnt_hi_u32_b32 v124, s49, v124
    v_lshlrev_b32 v125, 1, v124
    v_add_u32 v126, v125, v125
    s_bcnt1_i32_b64 s46, s[48:49]
    v_add_u32 v125, 133056, v125
    v_add_u32 v126, 106368, v126
    s_mov_b64 exec, s[48:49]
    ds_write_b32 v126, v8
    ds_write_b16 v125, v64
    s_mov_b64 exec, -1
    s_add_u32 s45, s45, s46
    v_mov_b32 v124, s45
    v_mbcnt_lo_u32_b32 v124, s50, v124
    v_mbcnt_hi_u32_b32 v124, s51, v124
    v_lshlrev_b32 v125, 1, v124
    v_add_u32 v126, v125, v125
    s_bcnt1_i32_b64 s46, s[50:51]
    v_add_u32 v125, 133056, v125
    v_add_u32 v126, 106368, v126
    s_mov_b64 exec, s[50:51]
    ds_write_b32 v126, v9
    ds_write_b16 v125, v65
    s_mov_b64 exec, -1
    s_add_u32 s45, s45, s46
    v_mov_b32 v124, s45
    v_mbcnt_lo_u32_b32 v124, s52, v124
    v_mbcnt_hi_u32_b32 v124, s53, v124
    v_lshlrev_b32 v125, 1, v124
    v_add_u32 v126, v125, v125
    s_bcnt1_i32_b64 s46, s[52:53]
    v_add_u32 v125, 133056, v125
    v_add_u32 v126, 106368, v126
    s_mov_b64 exec, s[52:53]
    ds_write_b32 v126, v10
    ds_write_b16 v125, v66
    s_mov_b64 exec, -1
    s_add_u32 s45, s45, s46
    v_mov_b32 v124, s45
    v_mbcnt_lo_u32_b32 v124, s54, v124
    v_mbcnt_hi_u32_b32 v124, s55, v124
    v_lshlrev_b32 v125, 1, v124
    v_add_u32 v126, v125, v125
    s_bcnt1_i32_b64 s46, s[54:55]
    v_add_u32 v125, 133056, v125
    v_add_u32 v126, 106368, v126
    s_mov_b64 exec, s[54:55]
    ds_write_b32 v126, v11
    ds_write_b16 v125, v67
    s_mov_b64 exec, -1
    s_add_u32 s45, s45, s46
    v_mov_b32 v124, s45
    v_mbcnt_lo_u32_b32 v124, s56, v124
    v_mbcnt_hi_u32_b32 v124, s57, v124
    v_lshlrev_b32 v125, 1, v124
    v_add_u32 v126, v125, v125
    s_bcnt1_i32_b64 s46, s[56:57]
    v_add_u32 v125, 133056, v125
    v_add_u32 v126, 106368, v126
    s_mov_b64 exec, s[56:57]
    ds_write_b32 v126, v12
    ds_write_b16 v125, v68
    s_mov_b64 exec, -1
    s_add_u32 s45, s45, s46
    v_mov_b32 v124, s45
    v_mbcnt_lo_u32_b32 v124, s58, v124
    v_mbcnt_hi_u32_b32 v124, s59, v124
    v_lshlrev_b32 v125, 1, v124
    v_add_u32 v126, v125, v125
    s_bcnt1_i32_b64 s46, s[58:59]
    v_add_u32 v125, 133056, v125
    v_add_u32 v126, 106368, v126
    s_mov_b64 exec, s[58:59]
    ds_write_b32 v126, v13
    ds_write_b16 v125, v69
    s_mov_b64 exec, -1
    s_add_u32 s45, s45, s46
    v_mov_b32 v124, s45
    v_mbcnt_lo_u32_b32 v124, s60, v124
    v_mbcnt_hi_u32_b32 v124, s61, v124
    v_lshlrev_b32 v125, 1, v124
    v_add_u32 v126, v125, v125
    s_bcnt1_i32_b64 s46, s[60:61]
    v_add_u32 v125, 133056, v125
    v_add_u32 v126, 106368, v126
    s_mov_b64 exec, s[60:61]
    ds_write_b32 v126, v14
    ds_write_b16 v125, v70
    s_mov_b64 exec, -1
    s_add_u32 s45, s45, s46
    v_mov_b32 v124, s45
    v_mbcnt_lo_u32_b32 v124, s62, v124
    v_mbcnt_hi_u32_b32 v124, s63, v124
    v_lshlrev_b32 v125, 1, v124
    v_add_u32 v126, v125, v125
    s_bcnt1_i32_b64 s46, s[62:63]
    v_add_u32 v125, 133056, v125
    v_add_u32 v126, 106368, v126
    s_mov_b64 exec, s[62:63]
    ds_write_b32 v126, v15
    ds_write_b16 v125, v71
    s_mov_b64 exec, -1
    s_add_u32 s45, s45, s46
    v_mov_b32 v124, s45
    v_mbcnt_lo_u32_b32 v124, s64, v124
    v_mbcnt_hi_u32_b32 v124, s65, v124
    v_lshlrev_b32 v125, 1, v124
    v_add_u32 v126, v125, v125
    s_bcnt1_i32_b64 s46, s[64:65]
    v_add_u32 v125, 133056, v125
    v_add_u32 v126, 106368, v126
    s_mov_b64 exec, s[64:65]
    ds_write_b32 v126, v16
    ds_write_b16 v125, v72
    s_mov_b64 exec, -1
    s_add_u32 s45, s45, s46
    v_mov_b32 v124, s45
    v_mbcnt_lo_u32_b32 v124, s66, v124
    v_mbcnt_hi_u32_b32 v124, s67, v124
    v_lshlrev_b32 v125, 1, v124
    v_add_u32 v126, v125, v125
    s_bcnt1_i32_b64 s46, s[66:67]
    v_add_u32 v125, 133056, v125
    v_add_u32 v126, 106368, v126
    s_mov_b64 exec, s[66:67]
    ds_write_b32 v126, v17
    ds_write_b16 v125, v73
    s_mov_b64 exec, -1
    s_add_u32 s45, s45, s46
    v_mov_b32 v124, s45
    v_mbcnt_lo_u32_b32 v124, s68, v124
    v_mbcnt_hi_u32_b32 v124, s69, v124
    v_lshlrev_b32 v125, 1, v124
    v_add_u32 v126, v125, v125
    s_bcnt1_i32_b64 s46, s[68:69]
    v_add_u32 v125, 133056, v125
    v_add_u32 v126, 106368, v126
    s_mov_b64 exec, s[68:69]
    ds_write_b32 v126, v18
    ds_write_b16 v125, v74
    s_mov_b64 exec, -1
    s_add_u32 s45, s45, s46
    v_mov_b32 v124, s45
    v_mbcnt_lo_u32_b32 v124, s70, v124
    v_mbcnt_hi_u32_b32 v124, s71, v124
    v_lshlrev_b32 v125, 1, v124
    v_add_u32 v126, v125, v125
    s_bcnt1_i32_b64 s46, s[70:71]
    v_add_u32 v125, 133056, v125
    v_add_u32 v126, 106368, v126
    s_mov_b64 exec, s[70:71]
    ds_write_b32 v126, v19
    ds_write_b16 v125, v75
    s_mov_b64 exec, -1
    s_add_u32 s45, s45, s46
    v_mov_b32 v124, s45
    v_mbcnt_lo_u32_b32 v124, s72, v124
    v_mbcnt_hi_u32_b32 v124, s73, v124
    v_lshlrev_b32 v125, 1, v124
    v_add_u32 v126, v125, v125
    s_bcnt1_i32_b64 s46, s[72:73]
    v_add_u32 v125, 133056, v125
    v_add_u32 v126, 106368, v126
    s_mov_b64 exec, s[72:73]
    ds_write_b32 v126, v20
    ds_write_b16 v125, v76
    s_mov_b64 exec, -1
    s_add_u32 s45, s45, s46
    s_cmp_ge_u32 s3, 1
    s_cbranch_scc1 K1E_P1DONE2
    v_mov_b32 v124, s45
    v_mbcnt_lo_u32_b32 v124, s74, v124
    v_mbcnt_hi_u32_b32 v124, s75, v124
    v_lshlrev_b32 v125, 1, v124
    v_add_u32 v126, v125, v125
    s_bcnt1_i32_b64 s46, s[74:75]
    v_add_u32 v125, 133056, v125
    v_add_u32 v126, 106368, v126
    s_mov_b64 exec, s[74:75]
    ds_write_b32 v126, v21
    ds_write_b16 v125, v77
    s_mov_b64 exec, -1
    s_add_u32 s45, s45, s46
K1E_P1DONE2:
    s_waitcnt lgkmcnt(0)
    s_barrier
    v_lshlrev_b32 v5, 5, v0
    v_add_u32 v5, 100096, v5
    v_mov_b32 v8, 0
    v_mov_b32 v9, 0
    v_mov_b32 v10, 0
    v_mov_b32 v11, 0
    v_mov_b32 v12, 0
    v_mov_b32 v13, 0
    v_mov_b32 v14, 0
    v_mov_b32 v15, 0
    v_cmp_gt_u32 vcc, 196, v0
    s_and_saveexec_b64 s[46:47], vcc
    ds_read_b128 v[8:11], v5
    ds_read_b128 v[12:15], v5 offset:16
    s_mov_b64 exec, s[46:47]
    s_waitcnt lgkmcnt(0)
    v_mov_b32 v16, 0
    v_mov_b32 v17, v8
    v_add_u32 v18, v17, v9
    v_add_u32 v19, v18, v10
    v_add_u32 v20, v19, v11
    v_add_u32 v21, v20, v12
    v_add_u32 v22, v21, v13
    v_add_u32 v23, v22, v14
    v_add_u32 v24, v23, v15
    v_mov_b32 v25, v24
    s_nop 1
    v_add_u32_dpp v25, v25, v25 row_shr:1 row_mask:0xf bank_mask:0xf bound_ctrl:0
    s_nop 1
    v_add_u32_dpp v25, v25, v25 row_shr:2 row_mask:0xf bank_mask:0xf bound_ctrl:0
    s_nop 1
    v_add_u32_dpp v25, v25, v25 row_shr:4 row_mask:0xf bank_mask:0xf bound_ctrl:0
    s_nop 1
    v_add_u32_dpp v25, v25, v25 row_shr:8 row_mask:0xf bank_mask:0xf bound_ctrl:0
    s_nop 1
    v_add_u32_dpp v25, v25, v25 row_bcast:15 row_mask:0xa bank_mask:0xf
    s_nop 1
    v_add_u32_dpp v25, v25, v25 row_bcast:31 row_mask:0xc bank_mask:0xf
    s_lshl_b32 s45, s3, 2
    s_add_u32 s45, s45, 146416
    v_mov_b32 v26, s45
    v_cmp_eq_u32 vcc, 63, v2
    s_and_saveexec_b64 s[46:47], vcc
    ds_write_b32 v26, v25
    s_mov_b64 exec, s[46:47]
    s_waitcnt lgkmcnt(0)
    s_barrier
    ds_read_b128 v[28:31], v6 offset:16
    ds_read_b128 v[32:35], v6 offset:32
    ds_read_b32 v36, v6
    v_sub_u32 v25, v25, v24
    s_waitcnt lgkmcnt(0)
    s_mov_b32 s45, 0
    v_readfirstlane_b32 s46, v28
    s_cmp_gt_u32 s3, 0
    s_cselect_b32 s46, s46, 0
    s_add_u32 s45, s45, s46
    v_readfirstlane_b32 s46, v29
    s_cmp_gt_u32 s3, 1
    s_cselect_b32 s46, s46, 0
    s_add_u32 s45, s45, s46
    v_readfirstlane_b32 s46, v30
    s_cmp_gt_u32 s3, 2
    s_cselect_b32 s46, s46, 0
    s_add_u32 s45, s45, s46
    v_readfirstlane_b32 s46, v31
    s_cmp_gt_u32 s3, 3
    s_cselect_b32 s46, s46, 0
    s_add_u32 s45, s45, s46
    v_readfirstlane_b32 s46, v32
    s_cmp_gt_u32 s3, 4
    s_cselect_b32 s46, s46, 0
    s_add_u32 s45, s45, s46
    v_readfirstlane_b32 s46, v33
    s_cmp_gt_u32 s3, 5
    s_cselect_b32 s46, s46, 0
    s_add_u32 s45, s45, s46
    v_readfirstlane_b32 s46, v34
    s_cmp_gt_u32 s3, 6
    s_cselect_b32 s46, s46, 0
    s_add_u32 s45, s45, s46
    v_readfirstlane_b32 s47, v36
    v_add_u32 v25, s45, v25
    v_add_u32 v16, v16, v25
    v_add_u32 v17, v17, v25
    v_add_u32 v18, v18, v25
    v_add_u32 v19, v19, v25
    v_add_u32 v20, v20, v25
    v_add_u32 v21, v21, v25
    v_add_u32 v22, v22, v25
    v_add_u32 v23, v23, v25
    v_lshlrev_b32 v27, 11, v0
    s_lshl_b32 s45, s2, 4
    v_lshl_or_b32 v28, v17, 16, v16
    v_lshl_or_b32 v29, v19, 16, v18
    v_mov_b32 v30, v20
    v_lshl_or_b32 v32, v21, 16, v20
    v_lshl_or_b32 v33, v23, 16, v22
    v_add_u32 v34, v16, v24
    v_cmp_gt_u32 vcc, 196, v0
    s_and_saveexec_b64 s[48:49], vcc
    ds_write_b128 v5, v[16:19]
    ds_write_b128 v5, v[20:23] offset:16
    buffer_store_dwordx3 v[28:30], v27, s[32:35], s45 offen
    buffer_store_dwordx3 v[32:34], v27, s[32:35], s45 offen offset:1024
    s_mov_b64 exec, s[48:49]
    s_waitcnt lgkmcnt(0)
    s_barrier
    s_mul_i32 s50, s2, 106752
    v_mov_b32 v1, v0
K1E_P3:
    v_cmp_gt_u32 vcc, s47, v1
    s_and_saveexec_b64 s[48:49], vcc
    s_cbranch_execz K1E_P3END
    v_lshlrev_b32 v3, 1, v1
    v_add_u32 v4, v3, v3
    v_add_u32 v3, 133056, v3
    v_add_u32 v4, 106368, v4
    ds_read_b32 v8, v4
    ds_read_u16 v9, v3
    s_waitcnt lgkmcnt(1)
    v_and_b32 v10, 0xffff, v8
    v_lshrrev_b32 v11, 16, v8
    v_lshlrev_b32 v12, 3, v10
    v_lshlrev_b32 v14, 3, v11
    ds_read_b64 v[16:17], v12
    ds_read_b64 v[18:19], v14
    v_lshrrev_b32 v20, 1, v11
    v_and_b32 v20, -4, v20
    v_add_u32 v20, 100096, v20
    ds_read_b32 v21, v20
    v_and_b32 v39, 3, v11
    v_or_b32 v44, 0xfffc, v39
    v_lshl_or_b32 v39, v10, 2, v39
    s_waitcnt lgkmcnt(1)
    v_and_b32 v22, 0xffff0000, v16
    v_and_b32 v23, 0xffff0000, v18
    v_lshlrev_b32 v16, 16, v16
    v_lshlrev_b32 v18, 16, v18
    v_sub_f32 v16, v16, v18
    v_sub_f32 v22, v22, v23
    v_sub_f32 v17, v17, v19
    v_cvt_pk_bf16_f32 v24, v16, v22
    v_cvt_pk_bf16_f32 v25, v17, v17
    v_lshlrev_b32 v16, 16, v24
    v_and_b32 v22, 0xffff0000, v24
    v_and_b32 v17, 0xffff0000, v25
    v_mul_f32 v26, v16, v16
    v_mul_f32 v27, v22, v22
    v_mul_f32 v28, v17, v17
    v_cvt_pk_bf16_f32 v24, v26, v27
    v_cvt_pk_bf16_f32 v25, v28, v28
    v_lshlrev_b32 v26, 16, v24
    v_and_b32 v27, 0xffff0000, v24
    v_and_b32 v28, 0xffff0000, v25
    v_add_f32 v26, v26, v27
    v_add_f32 v26, v26, v28
    v_cvt_pk_bf16_f32 v26, v26, v26
    v_and_b32 v26, 0xffff0000, v26
    v_add_f32 v26, 0x322bcc77, v26
    v_cvt_pk_bf16_f32 v26, v26, v26
    v_and_b32 v26, 0xffff0000, v26
    v_sqrt_f32 v26, v26
    s_nop 0
    v_cvt_pk_bf16_f32 v26, v26, v26
    v_and_b32 v26, 0xffff0000, v26
    v_rcp_f32 v27, v26
    v_mul_f32 v28, s38, v26
    v_mul_f32 v29, s39, v26
    v_mul_f32 v30, s40, v26
    v_mul_f32 v31, s41, v26
    v_mul_f32 v32, 0x40490fdb, v26
    v_cvt_pk_bf16_f32 v24, v28, v29
    v_lshlrev_b32 v28, 16, v24
    v_and_b32 v29, 0xffff0000, v24
    v_cvt_pk_bf16_f32 v25, v30, v31
    v_lshlrev_b32 v30, 16, v25
    v_and_b32 v31, 0xffff0000, v25
    v_cvt_pk_bf16_f32 v32, v32, v32
    v_and_b32 v32, 0xffff0000, v32
    v_mul_f32 v32, 0x3e4ccccd, v32
    v_cvt_pk_bf16_f32 v32, v32, v32
    v_and_b32 v32, 0xffff0000, v32
    v_mul_f32 v28, 0.15915494, v28
    v_mul_f32 v29, 0.15915494, v29
    v_mul_f32 v30, 0.15915494, v30
    v_mul_f32 v31, 0.15915494, v31
    v_mul_f32 v32, 0.15915494, v32
    v_fract_f32 v28, v28
    v_fract_f32 v29, v29
    v_fract_f32 v30, v30
    v_fract_f32 v31, v31
    v_fract_f32 v32, v32
    v_sin_f32 v28, v28
    v_sin_f32 v29, v29
    v_sin_f32 v30, v30
    v_sin_f32 v31, v31
    v_cos_f32 v32, v32
    v_mul_f32 v36, v16, v27
    v_mul_f32 v37, v22, v27
    v_mul_f32 v38, v17, v27
    v_cvt_pk_bf16_f32 v42, v36, v37
    v_cvt_pk_bf16_f32 v43, v38, v38
    v_cvt_pk_bf16_f32 v24, v28, v29
    v_lshlrev_b32 v28, 16, v24
    v_and_b32 v29, 0xffff0000, v24
    v_cvt_pk_bf16_f32 v25, v30, v31
    v_lshlrev_b32 v30, 16, v25
    v_and_b32 v31, 0xffff0000, v25
    v_cvt_pk_bf16_f32 v32, v32, v32
    v_and_b32 v32, 0xffff0000, v32
    v_mul_f32 v28, v28, v27
    v_mul_f32 v29, v29, v27
    v_mul_f32 v30, v30, v27
    v_mul_f32 v31, v31, v27
    v_add_f32 v32, 1.0, v32
    v_cvt_pk_bf16_f32 v24, v28, v29
    v_lshlrev_b32 v28, 16, v24
    v_and_b32 v29, 0xffff0000, v24
    v_cvt_pk_bf16_f32 v25, v30, v31
    v_lshlrev_b32 v30, 16, v25
    v_and_b32 v31, 0xffff0000, v25
    v_cvt_pk_bf16_f32 v32, v32, v32
    v_and_b32 v32, 0xffff0000, v32
    v_mul_f32 v32, 0.5, v32
    v_cmp_gt_f32 vcc, 0x40a00000, v26
    v_cmp_neq_f32 s[52:53], 0, v32
    v_mul_f32 v28, v28, v32
    v_mul_f32 v29, v29, v32
    v_mul_f32 v30, v30, v32
    v_mul_f32 v31, v31, v32
    s_and_b64 s[52:53], vcc, s[52:53]
    v_cvt_pk_bf16_f32 v40, v28, v29
    v_cvt_pk_bf16_f32 v41, v30, v31
    v_and_b32 v43, 0xffff, v43
    v_cndmask_b32 v39, v44, v39, s[52:53]
    v_cndmask_b32 v40, 0, v40, s[52:53]
    v_cndmask_b32 v41, 0, v41, s[52:53]
    v_cndmask_b32 v42, 0, v42, s[52:53]
    v_cndmask_b32 v43, 0, v43, s[52:53]
    v_lshl_or_b32 v43, v39, 16, v43
    v_and_b32 v24, 4, v11
    v_lshl_or_b32 v42, v24, 12, v42
    s_waitcnt lgkmcnt(0)
    v_add_u32 v21, v21, v9
    v_lshlrev_b32 v21, 4, v21
    buffer_store_dwordx4 v[40:43], v21, s[28:31], s50 offen
    s_mov_b64 exec, s[48:49]
    v_add_u32 v1, 512, v1
    s_branch K1E_P3
K1E_P3END:
    s_endpgm
K1_GEMM:
    s_load_dwordx2 s[4:5], s[0:1], 0
    s_load_dwordx4 s[8:11], s[0:1], 40
    s_load_dwordx2 s[46:47], s[0:1], 56
    s_load_dwordx2 s[12:13], s[0:1], 80
    v_lshrrev_b32 v1, 6, v0
    v_and_b32 v2, 63, v0
    v_readfirstlane_b32 s3, v1
    v_and_b32 v3, 15, v2
    v_lshrrev_b32 v4, 4, v2
    s_sub_u32 s14, s2, 60
    s_and_b32 s15, s3, 3
    s_lshr_b32 s36, s3, 2
    s_mul_i32 s43, s14, 64
    s_lshl_b32 s37, s36, 4
    s_add_u32 s37, s37, s43
    v_lshlrev_b32 v5, 4, v2
    v_mul_u32_u24 v6, 768, v4
    v_lshl_add_u32 v6, v3, 4, v6
    v_lshlrev_b32 v7, 10, v4
    v_lshl_add_u32 v7, v3, 4, v7
    v_lshlrev_b32 v13, 10, v3
    v_lshl_add_u32 v13, v4, 4, v13
    s_lshl_b32 s41, s15, 6
    v_add_u32 v13, s41, v13
    s_waitcnt lgkmcnt(0)
    s_mov_b32 s16, s4
    s_mov_b32 s17, s5
    s_mov_b32 s18, 12800000
    s_mov_b32 s19, 0x00020000
    s_mov_b32 s20, s8
    s_mov_b32 s21, s9
    s_mov_b32 s22, 32768
    s_mov_b32 s23, 0x00020000
    s_mov_b32 s24, s10
    s_mov_b32 s25, s11
    s_mov_b32 s26, 98304
    s_mov_b32 s27, 0x00020000
    s_lshr_b32 s44, s15, 1
    s_mul_i32 s44, s44, 8000000
    s_add_u32 s28, s12, s44
    s_addc_u32 s29, s13, 0
    s_mov_b32 s30, 8000000
    s_mov_b32 s31, 0x00020000
    s_cmp_lg_u32 s2, 255
    s_cbranch_scc1 K1G_NOWB
    s_cmp_lg_u32 s3, 7
    s_cbranch_scc1 K1G_NOWB
    s_mov_b32 s48, s46
    s_mov_b32 s49, s47
    s_mov_b32 s50, 3072
    s_mov_b32 s51, 0x00020000
    v_lshlrev_b32 v25, 2, v2
    buffer_load_dword v132, v25, s[48:51], 0 offen offset:0
    buffer_load_dword v133, v25, s[48:51], 0 offen offset:768
    buffer_load_dword v134, v25, s[48:51], 0 offen offset:1536
    buffer_load_dword v135, v25, s[48:51], 0 offen offset:2304
    buffer_load_dword v136, v25, s[48:51], 0 offen offset:256
    buffer_load_dword v137, v25, s[48:51], 0 offen offset:1024
    buffer_load_dword v138, v25, s[48:51], 0 offen offset:1792
    buffer_load_dword v139, v25, s[48:51], 0 offen offset:2560
    buffer_load_dword v140, v25, s[48:51], 0 offen offset:512
    buffer_load_dword v141, v25, s[48:51], 0 offen offset:1280
    buffer_load_dword v142, v25, s[48:51], 0 offen offset:2048
    buffer_load_dword v143, v25, s[48:51], 0 offen offset:2816
K1G_NOWB:
    s_lshl_b32 s38, s3, 12
    buffer_load_dwordx4 v[32:35], v5, s[20:23], s38 offen offset:0
    buffer_load_dwordx4 v[36:39], v5, s[20:23], s38 offen offset:1024
    buffer_load_dwordx4 v[40:43], v5, s[20:23], s38 offen offset:2048
    buffer_load_dwordx4 v[44:47], v5, s[20:23], s38 offen offset:3072
    s_lshl_b32 s39, s3, 2
    s_add_u32 s39, s39, s43
    s_lshl_b32 s39, s39, 10
    s_add_u32 s40, s39, 0
    buffer_load_dwordx4 v[48:51], v7, s[16:19], s40 offen
    s_add_u32 s40, s39, 32768
    buffer_load_dwordx4 v[52:55], v7, s[16:19], s40 offen
    v_lshrrev_b32 v8, 2, v3
    v_lshlrev_b32 v8, 9, v8
    v_and_b32 v9, 3, v3
    v_lshl_add_u32 v8, v9, 4, v8
    v_lshl_add_u32 v8, v4, 6, v8
    s_lshl_b32 s38, s3, 12
    v_add_u32 v9, s38, v8
    s_mul_i32 s38, s3, 12288
    s_add_u32 s38, s38, 32768
    v_add_u32 v10, s38, v8
    v_mul_u32_u24 v11, 272, v4
    v_lshl_add_u32 v11, v3, 4, v11
    s_mul_i32 s38, s3, 1088
    s_add_u32 s38, s38, 131072
    v_add_u32 v11, s38, v11
    v_lshrrev_b32 v14, 2, v3
    v_lshlrev_b32 v14, 6, v14
    v_and_b32 v15, 3, v3
    v_lshl_add_u32 v14, v15, 4, v14
    v_and_b32 v15, 1, v4
    v_lshl_add_u32 v14, v15, 3, v14
    s_lshl_b32 s41, s15, 9
    v_add_u32 v14, s41, v14
    v_lshl_add_u32 v16, v4, 11, v14
    v_xor_b32 v17, 8, v16
    v_mul_u32_u24 v18, 6144, v4
    v_add_u32 v18, v18, v14
    v_add_u32 v18, 32768, v18
    v_xor_b32 v19, 8, v18
    v_add_u32 v30, 49152, v18
    v_add_u32 v31, 49152, v19
    v_mul_u32_u24 v21, 272, v3
    v_lshl_add_u32 v21, v4, 4, v21
    s_mul_i32 s42, s36, 4352
    s_add_u32 s41, s42, 131072
    v_add_u32 v21, s41, v21
    s_lshl_b32 s41, s15, 6
    v_add_u32 v20, s41, v21
    v_add_u32 v22, 2048, v9
    s_waitcnt vmcnt(5)
    ds_write_b128 v9, v[32:35] offset:0
    s_waitcnt vmcnt(4)
    ds_write_b128 v9, v[36:39] offset:256
    s_waitcnt vmcnt(3)
    ds_write2_b64 v22, v[40:41], v[42:43] offset0:1 offset1:0
    s_waitcnt vmcnt(2)
    ds_write2_b64 v22, v[44:45], v[46:47] offset0:33 offset1:32
    s_waitcnt vmcnt(1)
    ds_write_b128 v11, v[48:51] offset:0
    s_waitcnt vmcnt(0)
    ds_write_b128 v11, v[52:55] offset:8704
K1G_SDONE:
    s_mul_i32 s38, s3, 12288
    s_add_u32 s40, s38, 0
    buffer_load_dwordx4 v[60:63], v6, s[24:27], s40 offen offset:0
    buffer_load_dwordx4 v[64:67], v6, s[24:27], s40 offen offset:256
    buffer_load_dwordx4 v[68:71], v6, s[24:27], s40 offen offset:512
    s_add_u32 s40, s38, 3072
    buffer_load_dwordx4 v[72:75], v6, s[24:27], s40 offen offset:0
    buffer_load_dwordx4 v[76:79], v6, s[24:27], s40 offen offset:256
    buffer_load_dwordx4 v[80:83], v6, s[24:27], s40 offen offset:512
    s_add_u32 s40, s38, 6144
    buffer_load_dwordx4 v[84:87], v6, s[24:27], s40 offen offset:0
    buffer_load_dwordx4 v[88:91], v6, s[24:27], s40 offen offset:256
    buffer_load_dwordx4 v[92:95], v6, s[24:27], s40 offen offset:512
    s_add_u32 s40, s38, 9216
    buffer_load_dwordx4 v[96:99], v6, s[24:27], s40 offen offset:0
    buffer_load_dwordx4 v[100:103], v6, s[24:27], s40 offen offset:256
    buffer_load_dwordx4 v[104:107], v6, s[24:27], s40 offen offset:512
    s_waitcnt lgkmcnt(0)
    s_barrier
    ds_read_b64_tr_b16 v[144:145], v16 offset:0
    ds_read_b64_tr_b16 v[146:147], v16 offset:256
    ds_read_b64_tr_b16 v[148:149], v16 offset:8192
    ds_read_b64_tr_b16 v[150:151], v16 offset:8448
    ds_read_b64_tr_b16 v[152:153], v16 offset:16384
    ds_read_b64_tr_b16 v[154:155], v16 offset:16640
    ds_read_b64_tr_b16 v[156:157], v16 offset:24576
    ds_read_b64_tr_b16 v[158:159], v16 offset:24832
    ds_read_b64_tr_b16 v[160:161], v17 offset:0
    ds_read_b64_tr_b16 v[162:163], v17 offset:256
    ds_read_b64_tr_b16 v[164:165], v17 offset:8192
    ds_read_b64_tr_b16 v[166:167], v17 offset:8448
    ds_read_b64_tr_b16 v[168:169], v17 offset:16384
    ds_read_b64_tr_b16 v[170:171], v17 offset:16640
    ds_read_b64_tr_b16 v[172:173], v17 offset:24576
    ds_read_b64_tr_b16 v[174:175], v17 offset:24832
    s_waitcnt lgkmcnt(8)
    ds_read_b128 v[176:179], v21 offset:0
    ds_read_b128 v[180:183], v21 offset:64
    ds_read_b128 v[184:187], v21 offset:128
    ds_read_b128 v[188:191], v21 offset:192
    s_waitcnt lgkmcnt(4)
    ds_read_b128 v[192:195], v21 offset:8704
    ds_read_b128 v[196:199], v21 offset:8768
    ds_read_b128 v[200:203], v21 offset:8832
    ds_read_b128 v[204:207], v21 offset:8896
    s_waitcnt lgkmcnt(0)
    v_mfma_f32_16x16x32_bf16 v[224:227], v[144:147], v[176:179], 0
    v_mfma_f32_16x16x32_bf16 v[224:227], v[148:151], v[180:183], v[224:227]
    v_mfma_f32_16x16x32_bf16 v[224:227], v[152:155], v[184:187], v[224:227]
    v_mfma_f32_16x16x32_bf16 v[224:227], v[156:159], v[188:191], v[224:227]
    v_mfma_f32_16x16x32_bf16 v[228:231], v[160:163], v[176:179], 0
    v_mfma_f32_16x16x32_bf16 v[228:231], v[164:167], v[180:183], v[228:231]
    v_mfma_f32_16x16x32_bf16 v[228:231], v[168:171], v[184:187], v[228:231]
    v_mfma_f32_16x16x32_bf16 v[228:231], v[172:175], v[188:191], v[228:231]
    v_mfma_f32_16x16x32_bf16 v[232:235], v[144:147], v[192:195], 0
    v_mfma_f32_16x16x32_bf16 v[232:235], v[148:151], v[196:199], v[232:235]
    v_mfma_f32_16x16x32_bf16 v[232:235], v[152:155], v[200:203], v[232:235]
    v_mfma_f32_16x16x32_bf16 v[232:235], v[156:159], v[204:207], v[232:235]
    v_mfma_f32_16x16x32_bf16 v[236:239], v[160:163], v[192:195], 0
    v_mfma_f32_16x16x32_bf16 v[236:239], v[164:167], v[196:199], v[236:239]
    v_mfma_f32_16x16x32_bf16 v[236:239], v[168:171], v[200:203], v[236:239]
    v_mfma_f32_16x16x32_bf16 v[236:239], v[172:175], v[204:207], v[236:239]
    s_add_u32 s39, s37, 0
    s_lshl_b32 s39, s39, 10
    buffer_load_dwordx4 v[108:111], v13, s[16:19], s39 offen offset:256
    buffer_load_dwordx4 v[112:115], v13, s[16:19], s39 offen offset:512
    buffer_load_dwordx4 v[116:119], v13, s[16:19], s39 offen offset:768
    s_barrier
    v_add_u32 v22, 6144, v10
    v_add_u32 v23, 2048, v22
    v_add_u32 v24, 4096, v22
    s_waitcnt vmcnt(14)
    ds_write_b128 v10, v[60:63] offset:0
    s_waitcnt vmcnt(13)
    ds_write_b128 v10, v[64:67] offset:2048
    s_waitcnt vmcnt(12)
    ds_write_b128 v10, v[68:71] offset:4096
    s_waitcnt vmcnt(11)
    ds_write_b128 v10, v[72:75] offset:256
    s_waitcnt vmcnt(10)
    ds_write_b128 v10, v[76:79] offset:2304
    s_waitcnt vmcnt(9)
    ds_write_b128 v10, v[80:83] offset:4352
    s_waitcnt vmcnt(8)
    ds_write2_b64 v22, v[84:85], v[86:87] offset0:1 offset1:0
    s_waitcnt vmcnt(7)
    ds_write2_b64 v23, v[88:89], v[90:91] offset0:1 offset1:0
    s_waitcnt vmcnt(6)
    ds_write2_b64 v24, v[92:93], v[94:95] offset0:1 offset1:0
    s_waitcnt vmcnt(5)
    ds_write2_b64 v22, v[96:97], v[98:99] offset0:33 offset1:32
    s_waitcnt vmcnt(4)
    ds_write2_b64 v23, v[100:101], v[102:103] offset0:33 offset1:32
    s_waitcnt vmcnt(3)
    ds_write2_b64 v24, v[104:105], v[106:107] offset0:33 offset1:32
    s_add_u32 s39, s37, 32
    s_lshl_b32 s39, s39, 10
    buffer_load_dwordx4 v[120:123], v13, s[16:19], s39 offen offset:256
    buffer_load_dwordx4 v[124:127], v13, s[16:19], s39 offen offset:512
    buffer_load_dwordx4 v[128:131], v13, s[16:19], s39 offen offset:768
    v_cvt_pk_bf16_f32 v248, v224, v225
    v_cvt_pk_bf16_f32 v249, v226, v227
    v_lshlrev_b32 v224, 16, v248
    v_and_b32 v225, 0xffff0000, v248
    v_lshlrev_b32 v226, 16, v249
    v_and_b32 v227, 0xffff0000, v249
    v_mul_f32 v248, 0xbfb8aa3b, v224
    v_mul_f32 v249, 0xbfb8aa3b, v225
    v_mul_f32 v250, 0xbfb8aa3b, v226
    v_mul_f32 v251, 0xbfb8aa3b, v227
    v_exp_f32 v248, v248
    v_exp_f32 v249, v249
    v_exp_f32 v250, v250
    v_exp_f32 v251, v251
    v_add_f32 v248, 1.0, v248
    v_add_f32 v249, 1.0, v249
    v_add_f32 v250, 1.0, v250
    v_add_f32 v251, 1.0, v251
    v_rcp_f32 v248, v248
    v_rcp_f32 v249, v249
    v_rcp_f32 v250, v250
    v_rcp_f32 v251, v251
    v_mul_f32 v224, v224, v248
    v_mul_f32 v225, v225, v249
    v_mul_f32 v226, v226, v250
    v_mul_f32 v227, v227, v251
    v_cvt_pk_bf16_f32 v32, v224, v225
    v_cvt_pk_bf16_f32 v33, v226, v227
    v_cvt_pk_bf16_f32 v252, v228, v229
    v_cvt_pk_bf16_f32 v253, v230, v231
    v_lshlrev_b32 v228, 16, v252
    v_and_b32 v229, 0xffff0000, v252
    v_lshlrev_b32 v230, 16, v253
    v_and_b32 v231, 0xffff0000, v253
    v_mul_f32 v252, 0xbfb8aa3b, v228
    v_mul_f32 v253, 0xbfb8aa3b, v229
    v_mul_f32 v254, 0xbfb8aa3b, v230
    v_mul_f32 v255, 0xbfb8aa3b, v231
    v_exp_f32 v252, v252
    v_exp_f32 v253, v253
    v_exp_f32 v254, v254
    v_exp_f32 v255, v255
    v_add_f32 v252, 1.0, v252
    v_add_f32 v253, 1.0, v253
    v_add_f32 v254, 1.0, v254
    v_add_f32 v255, 1.0, v255
    v_rcp_f32 v252, v252
    v_rcp_f32 v253, v253
    v_rcp_f32 v254, v254
    v_rcp_f32 v255, v255
    v_mul_f32 v228, v228, v252
    v_mul_f32 v229, v229, v253
    v_mul_f32 v230, v230, v254
    v_mul_f32 v231, v231, v255
    v_cvt_pk_bf16_f32 v34, v228, v229
    v_cvt_pk_bf16_f32 v35, v230, v231
    ds_write_b128 v20, v[32:35] offset:0
    v_cvt_pk_bf16_f32 v248, v232, v233
    v_cvt_pk_bf16_f32 v249, v234, v235
    v_lshlrev_b32 v232, 16, v248
    v_and_b32 v233, 0xffff0000, v248
    v_lshlrev_b32 v234, 16, v249
    v_and_b32 v235, 0xffff0000, v249
    v_mul_f32 v248, 0xbfb8aa3b, v232
    v_mul_f32 v249, 0xbfb8aa3b, v233
    v_mul_f32 v250, 0xbfb8aa3b, v234
    v_mul_f32 v251, 0xbfb8aa3b, v235
    v_exp_f32 v248, v248
    v_exp_f32 v249, v249
    v_exp_f32 v250, v250
    v_exp_f32 v251, v251
    v_add_f32 v248, 1.0, v248
    v_add_f32 v249, 1.0, v249
    v_add_f32 v250, 1.0, v250
    v_add_f32 v251, 1.0, v251
    v_rcp_f32 v248, v248
    v_rcp_f32 v249, v249
    v_rcp_f32 v250, v250
    v_rcp_f32 v251, v251
    v_mul_f32 v232, v232, v248
    v_mul_f32 v233, v233, v249
    v_mul_f32 v234, v234, v250
    v_mul_f32 v235, v235, v251
    v_cvt_pk_bf16_f32 v36, v232, v233
    v_cvt_pk_bf16_f32 v37, v234, v235
    v_cvt_pk_bf16_f32 v252, v236, v237
    v_cvt_pk_bf16_f32 v253, v238, v239
    v_lshlrev_b32 v236, 16, v252
    v_and_b32 v237, 0xffff0000, v252
    v_lshlrev_b32 v238, 16, v253
    v_and_b32 v239, 0xffff0000, v253
    v_mul_f32 v252, 0xbfb8aa3b, v236
    v_mul_f32 v253, 0xbfb8aa3b, v237
    v_mul_f32 v254, 0xbfb8aa3b, v238
    v_mul_f32 v255, 0xbfb8aa3b, v239
    v_exp_f32 v252, v252
    v_exp_f32 v253, v253
    v_exp_f32 v254, v254
    v_exp_f32 v255, v255
    v_add_f32 v252, 1.0, v252
    v_add_f32 v253, 1.0, v253
    v_add_f32 v254, 1.0, v254
    v_add_f32 v255, 1.0, v255
    v_rcp_f32 v252, v252
    v_rcp_f32 v253, v253
    v_rcp_f32 v254, v254
    v_rcp_f32 v255, v255
    v_mul_f32 v236, v236, v252
    v_mul_f32 v237, v237, v253
    v_mul_f32 v238, v238, v254
    v_mul_f32 v239, v239, v255
    v_cvt_pk_bf16_f32 v38, v236, v237
    v_cvt_pk_bf16_f32 v39, v238, v239
    ds_write_b128 v20, v[36:39] offset:8704
K1G_H_DONE:
    s_waitcnt lgkmcnt(0)
    s_barrier
    ds_read_b64_tr_b16 v[144:145], v18 offset:0
    ds_read_b64_tr_b16 v[146:147], v18 offset:256
    ds_read_b64_tr_b16 v[148:149], v18 offset:24576
    ds_read_b64_tr_b16 v[150:151], v18 offset:24832
    ds_read_b64_tr_b16 v[152:153], v18 offset:49152
    ds_read_b64_tr_b16 v[154:155], v18 offset:49408
    ds_read_b64_tr_b16 v[156:157], v30 offset:24576
    ds_read_b64_tr_b16 v[158:159], v30 offset:24832
    s_waitcnt lgkmcnt(4)
    ds_read_b64_tr_b16 v[160:161], v19 offset:0
    ds_read_b64_tr_b16 v[162:163], v19 offset:256
    ds_read_b64_tr_b16 v[164:165], v19 offset:24576
    ds_read_b64_tr_b16 v[166:167], v19 offset:24832
    ds_read_b64_tr_b16 v[168:169], v19 offset:49152
    ds_read_b64_tr_b16 v[170:171], v19 offset:49408
    ds_read_b64_tr_b16 v[172:173], v31 offset:24576
    ds_read_b64_tr_b16 v[174:175], v31 offset:24832
    s_waitcnt lgkmcnt(4)
    ds_read_b64_tr_b16 v[176:177], v18 offset:2048
    ds_read_b64_tr_b16 v[178:179], v18 offset:2304
    ds_read_b64_tr_b16 v[180:181], v18 offset:26624
    ds_read_b64_tr_b16 v[182:183], v18 offset:26880
    ds_read_b64_tr_b16 v[184:185], v18 offset:51200
    ds_read_b64_tr_b16 v[186:187], v18 offset:51456
    ds_read_b64_tr_b16 v[188:189], v30 offset:26624
    ds_read_b64_tr_b16 v[190:191], v30 offset:26880
    s_waitcnt lgkmcnt(4)
    ds_read_b64_tr_b16 v[192:193], v19 offset:2048
    ds_read_b64_tr_b16 v[194:195], v19 offset:2304
    ds_read_b64_tr_b16 v[196:197], v19 offset:26624
    ds_read_b64_tr_b16 v[198:199], v19 offset:26880
    ds_read_b64_tr_b16 v[200:201], v19 offset:51200
    ds_read_b64_tr_b16 v[202:203], v19 offset:51456
    ds_read_b64_tr_b16 v[204:205], v31 offset:26624
    ds_read_b64_tr_b16 v[206:207], v31 offset:26880
    s_waitcnt lgkmcnt(4)
    ds_read_b64_tr_b16 v[208:209], v18 offset:4096
    ds_read_b64_tr_b16 v[210:211], v18 offset:4352
    ds_read_b64_tr_b16 v[212:213], v18 offset:28672
    ds_read_b64_tr_b16 v[214:215], v18 offset:28928
    ds_read_b64_tr_b16 v[216:217], v18 offset:53248
    ds_read_b64_tr_b16 v[218:219], v18 offset:53504
    ds_read_b64_tr_b16 v[220:221], v30 offset:28672
    ds_read_b64_tr_b16 v[222:223], v30 offset:28928
    s_waitcnt lgkmcnt(4)
    ds_read_b64_tr_b16 v[224:225], v19 offset:4096
    ds_read_b64_tr_b16 v[226:227], v19 offset:4352
    ds_read_b64_tr_b16 v[228:229], v19 offset:28672
    ds_read_b64_tr_b16 v[230:231], v19 offset:28928
    ds_read_b64_tr_b16 v[232:233], v19 offset:53248
    ds_read_b64_tr_b16 v[234:235], v19 offset:53504
    ds_read_b64_tr_b16 v[236:237], v31 offset:28672
    ds_read_b64_tr_b16 v[238:239], v31 offset:28928
    s_waitcnt lgkmcnt(4)
    v_mul_u32_u24 v22, 640, v3
    v_lshl_add_u32 v22, v4, 4, v22
    s_and_b32 s41, s15, 1
    s_lshl_b32 s41, s41, 6
    v_add_u32 v23, s41, v22
    s_lshl_b32 s41, s41, 2
    v_add_u32 v22, s41, v22
    ds_read_b128 v[32:35], v21 offset:0
    ds_read_b128 v[36:39], v21 offset:64
    ds_read_b128 v[40:43], v21 offset:128
    ds_read_b128 v[44:47], v21 offset:192
    s_waitcnt lgkmcnt(0)
    v_mfma_f32_16x16x32_bf16 v[48:51], v[144:147], v[32:35], 0
    v_mfma_f32_16x16x32_bf16 v[48:51], v[148:151], v[36:39], v[48:51]
    v_mfma_f32_16x16x32_bf16 v[48:51], v[152:155], v[40:43], v[48:51]
    v_mfma_f32_16x16x32_bf16 v[48:51], v[156:159], v[44:47], v[48:51]
    v_mfma_f32_16x16x32_bf16 v[52:55], v[160:163], v[32:35], 0
    v_mfma_f32_16x16x32_bf16 v[52:55], v[164:167], v[36:39], v[52:55]
    v_mfma_f32_16x16x32_bf16 v[52:55], v[168:171], v[40:43], v[52:55]
    v_mfma_f32_16x16x32_bf16 v[52:55], v[172:175], v[44:47], v[52:55]
    v_mfma_f32_16x16x32_bf16 v[56:59], v[176:179], v[32:35], 0
    v_mfma_f32_16x16x32_bf16 v[56:59], v[180:183], v[36:39], v[56:59]
    v_mfma_f32_16x16x32_bf16 v[56:59], v[184:187], v[40:43], v[56:59]
    v_mfma_f32_16x16x32_bf16 v[56:59], v[188:191], v[44:47], v[56:59]
    v_mfma_f32_16x16x32_bf16 v[60:63], v[192:195], v[32:35], 0
    v_mfma_f32_16x16x32_bf16 v[60:63], v[196:199], v[36:39], v[60:63]
    v_mfma_f32_16x16x32_bf16 v[60:63], v[200:203], v[40:43], v[60:63]
    v_mfma_f32_16x16x32_bf16 v[60:63], v[204:207], v[44:47], v[60:63]
    v_mfma_f32_16x16x32_bf16 v[64:67], v[208:211], v[32:35], 0
    v_mfma_f32_16x16x32_bf16 v[64:67], v[212:215], v[36:39], v[64:67]
    v_mfma_f32_16x16x32_bf16 v[64:67], v[216:219], v[40:43], v[64:67]
    v_mfma_f32_16x16x32_bf16 v[64:67], v[220:223], v[44:47], v[64:67]
    v_mfma_f32_16x16x32_bf16 v[68:71], v[224:227], v[32:35], 0
    v_mfma_f32_16x16x32_bf16 v[68:71], v[228:231], v[36:39], v[68:71]
    v_mfma_f32_16x16x32_bf16 v[68:71], v[232:235], v[40:43], v[68:71]
    v_mfma_f32_16x16x32_bf16 v[68:71], v[236:239], v[44:47], v[68:71]
    s_add_u32 s39, s37, 0
    s_mul_i32 s39, s39, 640
    s_waitcnt vmcnt(3)
    v_cvt_pk_bf16_f32 v72, v48, v49
    v_cvt_pk_bf16_f32 v76, v50, v51
    v_cvt_pk_bf16_f32 v80, v52, v53
    v_cvt_pk_bf16_f32 v84, v54, v55
    v_cvt_pk_bf16_f32 v92, v56, v57
    v_cvt_pk_bf16_f32 v93, v58, v59
    v_cvt_pk_bf16_f32 v94, v60, v61
    v_cvt_pk_bf16_f32 v95, v62, v63
    v_lshlrev_b32 v56, 16, v92
    v_and_b32 v57, 0xffff0000, v92
    v_lshlrev_b32 v58, 16, v93
    v_and_b32 v59, 0xffff0000, v93
    v_lshlrev_b32 v60, 16, v94
    v_and_b32 v61, 0xffff0000, v94
    v_lshlrev_b32 v62, 16, v95
    v_and_b32 v63, 0xffff0000, v95
    v_cvt_pk_bf16_f32 v88, v64, v65
    v_cvt_pk_bf16_f32 v89, v66, v67
    v_cvt_pk_bf16_f32 v90, v68, v69
    v_cvt_pk_bf16_f32 v91, v70, v71
    v_lshlrev_b32 v92, 16, v108
    v_and_b32 v93, 0xffff0000, v108
    v_lshlrev_b32 v94, 16, v109
    v_and_b32 v95, 0xffff0000, v109
    v_lshlrev_b32 v96, 16, v110
    v_and_b32 v97, 0xffff0000, v110
    v_lshlrev_b32 v98, 16, v111
    v_and_b32 v99, 0xffff0000, v111
    v_mul_f32 v92, v92, v56
    v_mul_f32 v93, v93, v57
    v_mul_f32 v94, v94, v58
    v_mul_f32 v95, v95, v59
    v_mul_f32 v96, v96, v60
    v_mul_f32 v97, v97, v61
    v_mul_f32 v98, v98, v62
    v_mul_f32 v99, v99, v63
    v_cvt_pk_bf16_f32 v73, v92, v93
    v_cvt_pk_bf16_f32 v77, v94, v95
    v_cvt_pk_bf16_f32 v81, v96, v97
    v_cvt_pk_bf16_f32 v85, v98, v99
    v_lshlrev_b32 v92, 16, v112
    v_and_b32 v93, 0xffff0000, v112
    v_lshlrev_b32 v94, 16, v113
    v_and_b32 v95, 0xffff0000, v113
    v_lshlrev_b32 v96, 16, v114
    v_and_b32 v97, 0xffff0000, v114
    v_lshlrev_b32 v98, 16, v115
    v_and_b32 v99, 0xffff0000, v115
    v_mul_f32 v92, v92, v56
    v_mul_f32 v93, v93, v57
    v_mul_f32 v94, v94, v58
    v_mul_f32 v95, v95, v59
    v_mul_f32 v96, v96, v60
    v_mul_f32 v97, v97, v61
    v_mul_f32 v98, v98, v62
    v_mul_f32 v99, v99, v63
    v_cvt_pk_bf16_f32 v74, v92, v93
    v_cvt_pk_bf16_f32 v78, v94, v95
    v_cvt_pk_bf16_f32 v82, v96, v97
    v_cvt_pk_bf16_f32 v86, v98, v99
    v_lshlrev_b32 v92, 16, v116
    v_and_b32 v93, 0xffff0000, v116
    v_lshlrev_b32 v94, 16, v117
    v_and_b32 v95, 0xffff0000, v117
    v_lshlrev_b32 v96, 16, v118
    v_and_b32 v97, 0xffff0000, v118
    v_lshlrev_b32 v98, 16, v119
    v_and_b32 v99, 0xffff0000, v119
    v_mul_f32 v92, v92, v56
    v_mul_f32 v93, v93, v57
    v_mul_f32 v94, v94, v58
    v_mul_f32 v95, v95, v59
    v_mul_f32 v96, v96, v60
    v_mul_f32 v97, v97, v61
    v_mul_f32 v98, v98, v62
    v_mul_f32 v99, v99, v63
    v_cvt_pk_bf16_f32 v75, v92, v93
    v_cvt_pk_bf16_f32 v79, v94, v95
    v_cvt_pk_bf16_f32 v83, v96, v97
    v_cvt_pk_bf16_f32 v87, v98, v99
    buffer_store_dwordx4 v[72:75], v22, s[28:31], s39 offen offset:0 sc0 sc1
    buffer_store_dwordx4 v[76:79], v22, s[28:31], s39 offen offset:64 sc0 sc1
    buffer_store_dwordx4 v[80:83], v22, s[28:31], s39 offen offset:128 sc0 sc1
    buffer_store_dwordx4 v[84:87], v22, s[28:31], s39 offen offset:192 sc0 sc1
    buffer_store_dwordx4 v[88:91], v23, s[28:31], s39 offen offset:512 sc0 sc1
    ds_read_b128 v[32:35], v21 offset:8704
    ds_read_b128 v[36:39], v21 offset:8768
    ds_read_b128 v[40:43], v21 offset:8832
    ds_read_b128 v[44:47], v21 offset:8896
    s_waitcnt lgkmcnt(0)
    v_mfma_f32_16x16x32_bf16 v[48:51], v[144:147], v[32:35], 0
    v_mfma_f32_16x16x32_bf16 v[48:51], v[148:151], v[36:39], v[48:51]
    v_mfma_f32_16x16x32_bf16 v[48:51], v[152:155], v[40:43], v[48:51]
    v_mfma_f32_16x16x32_bf16 v[48:51], v[156:159], v[44:47], v[48:51]
    v_mfma_f32_16x16x32_bf16 v[52:55], v[160:163], v[32:35], 0
    v_mfma_f32_16x16x32_bf16 v[52:55], v[164:167], v[36:39], v[52:55]
    v_mfma_f32_16x16x32_bf16 v[52:55], v[168:171], v[40:43], v[52:55]
    v_mfma_f32_16x16x32_bf16 v[52:55], v[172:175], v[44:47], v[52:55]
    v_mfma_f32_16x16x32_bf16 v[56:59], v[176:179], v[32:35], 0
    v_mfma_f32_16x16x32_bf16 v[56:59], v[180:183], v[36:39], v[56:59]
    v_mfma_f32_16x16x32_bf16 v[56:59], v[184:187], v[40:43], v[56:59]
    v_mfma_f32_16x16x32_bf16 v[56:59], v[188:191], v[44:47], v[56:59]
    v_mfma_f32_16x16x32_bf16 v[60:63], v[192:195], v[32:35], 0
    v_mfma_f32_16x16x32_bf16 v[60:63], v[196:199], v[36:39], v[60:63]
    v_mfma_f32_16x16x32_bf16 v[60:63], v[200:203], v[40:43], v[60:63]
    v_mfma_f32_16x16x32_bf16 v[60:63], v[204:207], v[44:47], v[60:63]
    v_mfma_f32_16x16x32_bf16 v[64:67], v[208:211], v[32:35], 0
    v_mfma_f32_16x16x32_bf16 v[64:67], v[212:215], v[36:39], v[64:67]
    v_mfma_f32_16x16x32_bf16 v[64:67], v[216:219], v[40:43], v[64:67]
    v_mfma_f32_16x16x32_bf16 v[64:67], v[220:223], v[44:47], v[64:67]
    v_mfma_f32_16x16x32_bf16 v[68:71], v[224:227], v[32:35], 0
    v_mfma_f32_16x16x32_bf16 v[68:71], v[228:231], v[36:39], v[68:71]
    v_mfma_f32_16x16x32_bf16 v[68:71], v[232:235], v[40:43], v[68:71]
    v_mfma_f32_16x16x32_bf16 v[68:71], v[236:239], v[44:47], v[68:71]
    s_add_u32 s39, s37, 32
    s_mul_i32 s39, s39, 640
    s_waitcnt vmcnt(5)
    v_cvt_pk_bf16_f32 v72, v48, v49
    v_cvt_pk_bf16_f32 v76, v50, v51
    v_cvt_pk_bf16_f32 v80, v52, v53
    v_cvt_pk_bf16_f32 v84, v54, v55
    v_cvt_pk_bf16_f32 v92, v56, v57
    v_cvt_pk_bf16_f32 v93, v58, v59
    v_cvt_pk_bf16_f32 v94, v60, v61
    v_cvt_pk_bf16_f32 v95, v62, v63
    v_lshlrev_b32 v56, 16, v92
    v_and_b32 v57, 0xffff0000, v92
    v_lshlrev_b32 v58, 16, v93
    v_and_b32 v59, 0xffff0000, v93
    v_lshlrev_b32 v60, 16, v94
    v_and_b32 v61, 0xffff0000, v94
    v_lshlrev_b32 v62, 16, v95
    v_and_b32 v63, 0xffff0000, v95
    v_cvt_pk_bf16_f32 v88, v64, v65
    v_cvt_pk_bf16_f32 v89, v66, v67
    v_cvt_pk_bf16_f32 v90, v68, v69
    v_cvt_pk_bf16_f32 v91, v70, v71
    v_lshlrev_b32 v92, 16, v120
    v_and_b32 v93, 0xffff0000, v120
    v_lshlrev_b32 v94, 16, v121
    v_and_b32 v95, 0xffff0000, v121
    v_lshlrev_b32 v96, 16, v122
    v_and_b32 v97, 0xffff0000, v122
    v_lshlrev_b32 v98, 16, v123
    v_and_b32 v99, 0xffff0000, v123
    v_mul_f32 v92, v92, v56
    v_mul_f32 v93, v93, v57
    v_mul_f32 v94, v94, v58
    v_mul_f32 v95, v95, v59
    v_mul_f32 v96, v96, v60
    v_mul_f32 v97, v97, v61
    v_mul_f32 v98, v98, v62
    v_mul_f32 v99, v99, v63
    v_cvt_pk_bf16_f32 v73, v92, v93
    v_cvt_pk_bf16_f32 v77, v94, v95
    v_cvt_pk_bf16_f32 v81, v96, v97
    v_cvt_pk_bf16_f32 v85, v98, v99
    v_lshlrev_b32 v92, 16, v124
    v_and_b32 v93, 0xffff0000, v124
    v_lshlrev_b32 v94, 16, v125
    v_and_b32 v95, 0xffff0000, v125
    v_lshlrev_b32 v96, 16, v126
    v_and_b32 v97, 0xffff0000, v126
    v_lshlrev_b32 v98, 16, v127
    v_and_b32 v99, 0xffff0000, v127
    v_mul_f32 v92, v92, v56
    v_mul_f32 v93, v93, v57
    v_mul_f32 v94, v94, v58
    v_mul_f32 v95, v95, v59
    v_mul_f32 v96, v96, v60
    v_mul_f32 v97, v97, v61
    v_mul_f32 v98, v98, v62
    v_mul_f32 v99, v99, v63
    v_cvt_pk_bf16_f32 v74, v92, v93
    v_cvt_pk_bf16_f32 v78, v94, v95
    v_cvt_pk_bf16_f32 v82, v96, v97
    v_cvt_pk_bf16_f32 v86, v98, v99
    v_lshlrev_b32 v92, 16, v128
    v_and_b32 v93, 0xffff0000, v128
    v_lshlrev_b32 v94, 16, v129
    v_and_b32 v95, 0xffff0000, v129
    v_lshlrev_b32 v96, 16, v130
    v_and_b32 v97, 0xffff0000, v130
    v_lshlrev_b32 v98, 16, v131
    v_and_b32 v99, 0xffff0000, v131
    v_mul_f32 v92, v92, v56
    v_mul_f32 v93, v93, v57
    v_mul_f32 v94, v94, v58
    v_mul_f32 v95, v95, v59
    v_mul_f32 v96, v96, v60
    v_mul_f32 v97, v97, v61
    v_mul_f32 v98, v98, v62
    v_mul_f32 v99, v99, v63
    v_cvt_pk_bf16_f32 v75, v92, v93
    v_cvt_pk_bf16_f32 v79, v94, v95
    v_cvt_pk_bf16_f32 v83, v96, v97
    v_cvt_pk_bf16_f32 v87, v98, v99
    buffer_store_dwordx4 v[72:75], v22, s[28:31], s39 offen offset:0 sc0 sc1
    buffer_store_dwordx4 v[76:79], v22, s[28:31], s39 offen offset:64 sc0 sc1
    buffer_store_dwordx4 v[80:83], v22, s[28:31], s39 offen offset:128 sc0 sc1
    buffer_store_dwordx4 v[84:87], v22, s[28:31], s39 offen offset:192 sc0 sc1
    buffer_store_dwordx4 v[88:91], v23, s[28:31], s39 offen offset:512 sc0 sc1
K1G_END:
    s_cmp_lg_u32 s2, 255
    s_cbranch_scc1 K1_END
    s_cmp_eq_u32 s3, 7
    s_cbranch_scc1 K1_WBT
K1_END:
    s_endpgm
K1_WBT:
    s_mov_b64 exec, -1
    v_mul_u32_u24 v2, 48, v2
    s_mov_b32 s44, 0x05040100
    s_mov_b32 s45, 0x07060302
    s_add_u32 s20, s12, 0x2100000
    s_addc_u32 s21, s13, 0
    s_mov_b32 s22, 3072
    s_mov_b32 s23, 0x00020000
    v_perm_b32 v32, v133, v132, s44
    v_perm_b32 v33, v135, v134, s44
    v_perm_b32 v34, v133, v132, s45
    v_perm_b32 v35, v135, v134, s45
    v_perm_b32 v36, v137, v136, s44
    v_perm_b32 v37, v139, v138, s44
    v_perm_b32 v38, v137, v136, s45
    v_perm_b32 v39, v139, v138, s45
    v_perm_b32 v40, v141, v140, s44
    v_perm_b32 v41, v143, v142, s44
    v_perm_b32 v42, v141, v140, s45
    v_perm_b32 v43, v143, v142, s45
    buffer_store_dwordx4 v[32:35], v2, s[20:23], 0 offen offset:0
    buffer_store_dwordx4 v[36:39], v2, s[20:23], 0 offen offset:16
    buffer_store_dwordx4 v[40:43], v2, s[20:23], 0 offen offset:32
    s_endpgm
.globl painn_main_kernel
.p2align 8
.type painn_main_kernel,@function
painn_main_kernel:
    s_load_dwordx2 s[4:5], s[0:1], 0
    s_load_dwordx2 s[10:11], s[0:1], 64
    s_load_dwordx2 s[12:13], s[0:1], 80
    s_cmp_ge_u32 s2, 3128
    s_cbranch_scc1 K2_END
    s_and_b32 s3, s2, 1
    s_bfe_u32 s14, s2, 0x20001
    s_mul_i32 s14, s14, 391
    s_lshr_b32 s15, s2, 3
    s_add_u32 s14, s14, s15
    s_cmp_ge_u32 s14, 1563
    s_cbranch_scc1 K2_END
    v_lshlrev_b32 v10, 2, v0
    v_and_b32 v11, 31, v0
    s_lshl_b32 s15, s3, 5
    v_add_u32 v12, s15, v11
    v_mul_u32_u24 v12, 48, v12
    s_lshr_b32 s40, s14, 2
    s_lshl_b32 s40, s40, 10
    s_and_b32 s86, s14, 2
    s_lshl_b32 s86, s86, 1
    s_add_u32 s40, s40, s86
    s_and_b32 s86, s14, 1
    s_lshl_b32 s86, s86, 4
    v_lshlrev_b32 v13, 4, v0
    s_waitcnt lgkmcnt(0)
    s_add_u32 s24, s12, 0x2000000
    s_addc_u32 s25, s13, 0
    s_mov_b32 s26, 401408
    s_mov_b32 s27, 0x00020000
    buffer_load_dwordx2 v[8:9], v13, s[24:27], s40 offen
    s_add_u32 s36, s12, 0x2100000
    s_addc_u32 s37, s13, 0
    s_mov_b32 s38, 3072
    s_mov_b32 s39, 0x00020000
    buffer_load_dwordx4 v[24:27], v12, s[36:39], 0 offen offset:0
    buffer_load_dwordx4 v[28:31], v12, s[36:39], 0 offen offset:16
    buffer_load_dwordx4 v[32:35], v12, s[36:39], 0 offen offset:32
    s_add_u32 s20, s12, 0x1000000
    s_addc_u32 s21, s13, 0
    s_mov_b32 s22, 6405120
    s_mov_b32 s23, 0x00020000
    s_mul_i32 s44, s3, 8000000
    s_add_u32 s16, s12, s44
    s_addc_u32 s17, s13, 0
    s_mov_b32 s18, 8000000
    s_mov_b32 s19, 0x00020000
    s_mov_b32 s28, s4
    s_mov_b32 s29, s5
    s_mov_b32 s30, 12800000
    s_mov_b32 s31, 0x00020000
    s_mov_b32 s32, s10
    s_mov_b32 s33, s11
    s_mov_b32 s34, 12800000
    s_mov_b32 s35, 0x00020000
    v_and_b32 v14, 3, v11
    v_lshlrev_b32 v4, 5, v14
    v_lshlrev_b32 v14, 6, v14
    v_bfe_u32 v15, v11, 2, 2
    v_lshl_add_u32 v1, v15, 4, v14
    v_lshrrev_b32 v15, 4, v11
    v_lshl_add_u32 v1, v15, 8, v1
    v_lshlrev_b32 v2, 2, v11
    s_lshl_b32 s15, s3, 7
    v_add_u32 v3, s15, v2
    s_lshl_b32 s41, s14, 13
    v_add_u32 v3, s41, v3
    s_mov_b32 s42, 0
K2_ROUND:
    v_mul_u32_u24 v14, 1668, v0
    v_lshlrev_b32 v14, 6, v14
    v_mov_b32 v15, 0
    v_lshlrev_b32 v10, 2, v0
    s_mov_b64 exec, 0xffff
    ds_write_b32 v10, v15 offset:0
    s_mov_b64 exec, -1
    s_waitcnt vmcnt(3)
    v_alignbit_b32 v13, v9, v8, s86
    v_lshrrev_b32 v45, 16, v13
    v_and_b32 v13, 0xffff, v13
    v_sub_u32 v45, v45, v13
    v_cmp_gt_u32 s[58:59], 60, v0
    s_nop 1
    v_cndmask_b32 v45, 0, v45, s[58:59]
    v_lshl_add_u32 v44, v13, 4, v14
    s_mov_b32 s46, 0
    s_mov_b32 s61, 0
    s_add_u32 s47, s42, 0
    v_cmp_lt_u32 s[62:63], s47, v45
    s_lshl_b32 s47, s47, 4
    s_bcnt1_i32_b64 s58, s[62:63]
    s_cbranch_scc0 K2_LVDONE
    s_add_u32 s59, s46, s58
    s_cmp_gt_u32 s59, 120
    s_cbranch_scc1 K2_LVDONE
    s_mov_b32 s46, s59
    s_mov_b32 s61, 1
    s_mov_b64 exec, s[62:63]
    buffer_load_dwordx4 v[68:71], v44, s[20:23], s47 offen
    s_mov_b64 exec, -1
    s_add_u32 s47, s42, 1
    v_cmp_lt_u32 s[64:65], s47, v45
    s_lshl_b32 s47, s47, 4
    s_bcnt1_i32_b64 s58, s[64:65]
    s_cbranch_scc0 K2_LVDONE
    s_add_u32 s59, s46, s58
    s_cmp_gt_u32 s59, 120
    s_cbranch_scc1 K2_LVDONE
    s_mov_b32 s46, s59
    s_mov_b32 s61, 2
    s_mov_b64 exec, s[64:65]
    buffer_load_dwordx4 v[72:75], v44, s[20:23], s47 offen
    s_mov_b64 exec, -1
    s_add_u32 s47, s42, 2
    v_cmp_lt_u32 s[66:67], s47, v45
    s_lshl_b32 s47, s47, 4
    s_bcnt1_i32_b64 s58, s[66:67]
    s_cbranch_scc0 K2_LVDONE
    s_add_u32 s59, s46, s58
    s_cmp_gt_u32 s59, 120
    s_cbranch_scc1 K2_LVDONE
    s_mov_b32 s46, s59
    s_mov_b32 s61, 3
    s_mov_b64 exec, s[66:67]
    buffer_load_dwordx4 v[76:79], v44, s[20:23], s47 offen
    s_mov_b64 exec, -1
    s_add_u32 s47, s42, 3
    v_cmp_lt_u32 s[68:69], s47, v45
    s_lshl_b32 s47, s47, 4
    s_bcnt1_i32_b64 s58, s[68:69]
    s_cbranch_scc0 K2_LVDONE
    s_add_u32 s59, s46, s58
    s_cmp_gt_u32 s59, 120
    s_cbranch_scc1 K2_LVDONE
    s_mov_b32 s46, s59
    s_mov_b32 s61, 4
    s_mov_b64 exec, s[68:69]
    buffer_load_dwordx4 v[80:83], v44, s[20:23], s47 offen
    s_mov_b64 exec, -1
    s_add_u32 s47, s42, 4
    v_cmp_lt_u32 s[70:71], s47, v45
    s_lshl_b32 s47, s47, 4
    s_bcnt1_i32_b64 s58, s[70:71]
    s_cbranch_scc0 K2_LVDONE
    s_add_u32 s59, s46, s58
    s_cmp_gt_u32 s59, 120
    s_cbranch_scc1 K2_LVDONE
    s_mov_b32 s46, s59
    s_mov_b32 s61, 5
    s_mov_b64 exec, s[70:71]
    buffer_load_dwordx4 v[84:87], v44, s[20:23], s47 offen
    s_mov_b64 exec, -1
    s_add_u32 s47, s42, 5
    v_cmp_lt_u32 s[72:73], s47, v45
    s_lshl_b32 s47, s47, 4
    s_bcnt1_i32_b64 s58, s[72:73]
    s_cbranch_scc0 K2_LVDONE
    s_add_u32 s59, s46, s58
    s_cmp_gt_u32 s59, 120
    s_cbranch_scc1 K2_LVDONE
    s_mov_b32 s46, s59
    s_mov_b32 s61, 6
    s_mov_b64 exec, s[72:73]
    buffer_load_dwordx4 v[88:91], v44, s[20:23], s47 offen
    s_mov_b64 exec, -1
    s_add_u32 s47, s42, 6
    v_cmp_lt_u32 s[74:75], s47, v45
    s_lshl_b32 s47, s47, 4
    s_bcnt1_i32_b64 s58, s[74:75]
    s_cbranch_scc0 K2_LVDONE
    s_add_u32 s59, s46, s58
    s_cmp_gt_u32 s59, 120
    s_cbranch_scc1 K2_LVDONE
    s_mov_b32 s46, s59
    s_mov_b32 s61, 7
    s_mov_b64 exec, s[74:75]
    buffer_load_dwordx4 v[92:95], v44, s[20:23], s47 offen
    s_mov_b64 exec, -1
    s_add_u32 s47, s42, 7
    v_cmp_lt_u32 s[76:77], s47, v45
    s_lshl_b32 s47, s47, 4
    s_bcnt1_i32_b64 s58, s[76:77]
    s_cbranch_scc0 K2_LVDONE
    s_add_u32 s59, s46, s58
    s_cmp_gt_u32 s59, 120
    s_cbranch_scc1 K2_LVDONE
    s_mov_b32 s46, s59
    s_mov_b32 s61, 8
    s_mov_b64 exec, s[76:77]
    buffer_load_dwordx4 v[96:99], v44, s[20:23], s47 offen
    s_mov_b64 exec, -1
    s_add_u32 s47, s42, 8
    v_cmp_lt_u32 s[78:79], s47, v45
    s_lshl_b32 s47, s47, 4
    s_bcnt1_i32_b64 s58, s[78:79]
    s_cbranch_scc0 K2_LVDONE
    s_add_u32 s59, s46, s58
    s_cmp_gt_u32 s59, 120
    s_cbranch_scc1 K2_LVDONE
    s_mov_b32 s46, s59
    s_mov_b32 s61, 9
    s_mov_b64 exec, s[78:79]
    buffer_load_dwordx4 v[100:103], v44, s[20:23], s47 offen
    s_mov_b64 exec, -1
    s_add_u32 s47, s42, 9
    v_cmp_lt_u32 s[80:81], s47, v45
    s_lshl_b32 s47, s47, 4
    s_bcnt1_i32_b64 s58, s[80:81]
    s_cbranch_scc0 K2_LVDONE
    s_add_u32 s59, s46, s58
    s_cmp_gt_u32 s59, 120
    s_cbranch_scc1 K2_LVDONE
    s_mov_b32 s46, s59
    s_mov_b32 s61, 10
    s_mov_b64 exec, s[80:81]
    buffer_load_dwordx4 v[104:107], v44, s[20:23], s47 offen
    s_mov_b64 exec, -1
    s_add_u32 s47, s42, 10
    v_cmp_lt_u32 s[82:83], s47, v45
    s_lshl_b32 s47, s47, 4
    s_bcnt1_i32_b64 s58, s[82:83]
    s_cbranch_scc0 K2_LVDONE
    s_add_u32 s59, s46, s58
    s_cmp_gt_u32 s59, 120
    s_cbranch_scc1 K2_LVDONE
    s_mov_b32 s46, s59
    s_mov_b32 s61, 11
    s_mov_b64 exec, s[82:83]
    buffer_load_dwordx4 v[108:111], v44, s[20:23], s47 offen
    s_mov_b64 exec, -1
    s_add_u32 s47, s42, 11
    v_cmp_lt_u32 s[84:85], s47, v45
    s_lshl_b32 s47, s47, 4
    s_bcnt1_i32_b64 s58, s[84:85]
    s_cbranch_scc0 K2_LVDONE
    s_add_u32 s59, s46, s58
    s_cmp_gt_u32 s59, 120
    s_cbranch_scc1 K2_LVDONE
    s_mov_b32 s46, s59
    s_mov_b32 s61, 12
    s_mov_b64 exec, s[84:85]
    buffer_load_dwordx4 v[112:115], v44, s[20:23], s47 offen
    s_mov_b64 exec, -1
K2_LVDONE:
    s_add_u32 s42, s42, s61
    v_cmp_lt_u32 vcc, s42, v45
    s_mov_b32 s43, 0
    s_cbranch_vccz K2_NOMORE
    s_mov_b32 s43, 1
K2_NOMORE:
    v_mov_b32 v15, 1
    s_waitcnt vmcnt(0)
    s_cmp_le_u32 s61, 0
    s_cbranch_scc1 K2_CNTDONE
    v_bfe_u32 v10, v71, 16, 2
    v_bfe_u32 v11, v70, 14, 1
    v_lshl_or_b32 v10, v11, 2, v10
    v_lshlrev_b32 v116, 2, v10
    s_mov_b64 exec, s[62:63]
    ds_add_rtn_u32 v46, v116, v15 offset:0
    s_mov_b64 exec, -1
    s_cmp_le_u32 s61, 1
    s_cbranch_scc1 K2_CNTDONE
    v_bfe_u32 v10, v75, 16, 2
    v_bfe_u32 v11, v74, 14, 1
    v_lshl_or_b32 v10, v11, 2, v10
    v_lshlrev_b32 v117, 2, v10
    s_mov_b64 exec, s[64:65]
    ds_add_rtn_u32 v47, v117, v15 offset:0
    s_mov_b64 exec, -1
    s_cmp_le_u32 s61, 2
    s_cbranch_scc1 K2_CNTDONE
    v_bfe_u32 v10, v79, 16, 2
    v_bfe_u32 v11, v78, 14, 1
    v_lshl_or_b32 v10, v11, 2, v10
    v_lshlrev_b32 v118, 2, v10
    s_mov_b64 exec, s[66:67]
    ds_add_rtn_u32 v48, v118, v15 offset:0
    s_mov_b64 exec, -1
    s_cmp_le_u32 s61, 3
    s_cbranch_scc1 K2_CNTDONE
    v_bfe_u32 v10, v83, 16, 2
    v_bfe_u32 v11, v82, 14, 1
    v_lshl_or_b32 v10, v11, 2, v10
    v_lshlrev_b32 v119, 2, v10
    s_mov_b64 exec, s[68:69]
    ds_add_rtn_u32 v49, v119, v15 offset:0
    s_mov_b64 exec, -1
    s_cmp_le_u32 s61, 4
    s_cbranch_scc1 K2_CNTDONE
    v_bfe_u32 v10, v87, 16, 2
    v_bfe_u32 v11, v86, 14, 1
    v_lshl_or_b32 v10, v11, 2, v10
    v_lshlrev_b32 v120, 2, v10
    s_mov_b64 exec, s[70:71]
    ds_add_rtn_u32 v50, v120, v15 offset:0
    s_mov_b64 exec, -1
    s_cmp_le_u32 s61, 5
    s_cbranch_scc1 K2_CNTDONE
    v_bfe_u32 v10, v91, 16, 2
    v_bfe_u32 v11, v90, 14, 1
    v_lshl_or_b32 v10, v11, 2, v10
    v_lshlrev_b32 v121, 2, v10
    s_mov_b64 exec, s[72:73]
    ds_add_rtn_u32 v51, v121, v15 offset:0
    s_mov_b64 exec, -1
    s_cmp_le_u32 s61, 6
    s_cbranch_scc1 K2_CNTDONE
    v_bfe_u32 v10, v95, 16, 2
    v_bfe_u32 v11, v94, 14, 1
    v_lshl_or_b32 v10, v11, 2, v10
    v_lshlrev_b32 v122, 2, v10
    s_mov_b64 exec, s[74:75]
    ds_add_rtn_u32 v52, v122, v15 offset:0
    s_mov_b64 exec, -1
    s_cmp_le_u32 s61, 7
    s_cbranch_scc1 K2_CNTDONE
    v_bfe_u32 v10, v99, 16, 2
    v_bfe_u32 v11, v98, 14, 1
    v_lshl_or_b32 v10, v11, 2, v10
    v_lshlrev_b32 v123, 2, v10
    s_mov_b64 exec, s[76:77]
    ds_add_rtn_u32 v53, v123, v15 offset:0
    s_mov_b64 exec, -1
    s_cmp_le_u32 s61, 8
    s_cbranch_scc1 K2_CNTDONE
    v_bfe_u32 v10, v103, 16, 2
    v_bfe_u32 v11, v102, 14, 1
    v_lshl_or_b32 v10, v11, 2, v10
    v_lshlrev_b32 v124, 2, v10
    s_mov_b64 exec, s[78:79]
    ds_add_rtn_u32 v54, v124, v15 offset:0
    s_mov_b64 exec, -1
    s_cmp_le_u32 s61, 9
    s_cbranch_scc1 K2_CNTDONE
    v_bfe_u32 v10, v107, 16, 2
    v_bfe_u32 v11, v106, 14, 1
    v_lshl_or_b32 v10, v11, 2, v10
    v_lshlrev_b32 v125, 2, v10
    s_mov_b64 exec, s[80:81]
    ds_add_rtn_u32 v55, v125, v15 offset:0
    s_mov_b64 exec, -1
    s_cmp_le_u32 s61, 10
    s_cbranch_scc1 K2_CNTDONE
    v_bfe_u32 v10, v111, 16, 2
    v_bfe_u32 v11, v110, 14, 1
    v_lshl_or_b32 v10, v11, 2, v10
    v_lshlrev_b32 v126, 2, v10
    s_mov_b64 exec, s[82:83]
    ds_add_rtn_u32 v56, v126, v15 offset:0
    s_mov_b64 exec, -1
    s_cmp_le_u32 s61, 11
    s_cbranch_scc1 K2_CNTDONE
    v_bfe_u32 v10, v115, 16, 2
    v_bfe_u32 v11, v114, 14, 1
    v_lshl_or_b32 v10, v11, 2, v10
    v_lshlrev_b32 v127, 2, v10
    s_mov_b64 exec, s[84:85]
    ds_add_rtn_u32 v57, v127, v15 offset:0
    s_mov_b64 exec, -1
K2_CNTDONE:
    v_mov_b32 v14, 0
    v_and_b32 v5, 60, v2
    ds_read_b32 v10, v5 offset:0
    ds_read_b128 v[60:63], v14 offset:0
    ds_read_b128 v[64:67], v14 offset:16
    ds_read_b128 v[36:39], v14 offset:32
    ds_read_b128 v[40:43], v14 offset:48
    v_lshrrev_b32 v13, 2, v5
    s_waitcnt lgkmcnt(4)
    v_add_u32 v11, 1, v10
    v_mov_b32 v12, v11
    s_nop 1
    v_add_u32_dpp v12, v12, v12 row_shr:1 row_mask:0xf bank_mask:0xf bound_ctrl:0
    s_nop 1
    v_add_u32_dpp v12, v12, v12 row_shr:2 row_mask:0xf bank_mask:0xf bound_ctrl:0
    s_nop 1
    v_add_u32_dpp v12, v12, v12 row_shr:4 row_mask:0xf bank_mask:0xf bound_ctrl:0
    s_nop 1
    v_add_u32_dpp v12, v12, v12 row_shr:8 row_mask:0xf bank_mask:0xf bound_ctrl:0
    v_sub_u32 v12, v12, v11
    v_lshlrev_b32 v12, 5, v12
    v_add_u32 v12, 256, v12
    ds_write_b32 v5, v12 offset:64
    v_lshl_add_u32 v9, v10, 5, v12
    v_lshlrev_b32 v15, 4, v10
    v_sub_u32 v15, v15, v13
    v_add_u32 v15, 15, v15
    v_mov_b32 v14, 0
    s_waitcnt lgkmcnt(1)
    v_lshl_add_u32 v60, v60, 4, 15
    v_lshl_add_u32 v61, v61, 4, 14
    v_lshl_add_u32 v62, v62, 4, 13
    v_lshl_add_u32 v63, v63, 4, 12
    v_lshl_add_u32 v64, v64, 4, 11
    v_lshl_add_u32 v65, v65, 4, 10
    v_lshl_add_u32 v66, v66, 4, 9
    v_lshl_add_u32 v67, v67, 4, 8
    v_lshl_add_u32 v36, v36, 4, 7
    v_lshl_add_u32 v37, v37, 4, 6
    v_lshl_add_u32 v38, v38, 4, 5
    v_lshl_add_u32 v39, v39, 4, 4
    v_lshl_add_u32 v40, v40, 4, 3
    v_lshl_add_u32 v41, v41, 4, 2
    v_lshl_add_u32 v42, v42, 4, 1
    v_lshl_add_u32 v43, v43, 4, 0
    v_cmp_gt_u32 s[48:49], v60, v15
    v_cmp_gt_u32 s[50:51], v61, v15
    v_cmp_gt_u32 s[52:53], v62, v15
    v_cmp_gt_u32 s[54:55], v63, v15
    v_addc_co_u32 v14, s[56:57], 0, v14, s[48:49]
    v_addc_co_u32 v14, s[56:57], 0, v14, s[50:51]
    v_addc_co_u32 v14, s[56:57], 0, v14, s[52:53]
    v_addc_co_u32 v14, s[56:57], 0, v14, s[54:55]
    v_cmp_gt_u32 s[48:49], v64, v15
    v_cmp_gt_u32 s[50:51], v65, v15
    v_cmp_gt_u32 s[52:53], v66, v15
    v_cmp_gt_u32 s[54:55], v67, v15
    v_addc_co_u32 v14, s[56:57], 0, v14, s[48:49]
    v_addc_co_u32 v14, s[56:57], 0, v14, s[50:51]
    v_addc_co_u32 v14, s[56:57], 0, v14, s[52:53]
    v_addc_co_u32 v14, s[56:57], 0, v14, s[54:55]
    v_cmp_gt_u32 s[48:49], v36, v15
    v_cmp_gt_u32 s[50:51], v37, v15
    v_cmp_gt_u32 s[52:53], v38, v15
    v_cmp_gt_u32 s[54:55], v39, v15
    v_addc_co_u32 v14, s[56:57], 0, v14, s[48:49]
    v_addc_co_u32 v14, s[56:57], 0, v14, s[50:51]
    v_addc_co_u32 v14, s[56:57], 0, v14, s[52:53]
    v_addc_co_u32 v14, s[56:57], 0, v14, s[54:55]
    v_cmp_gt_u32 s[48:49], v40, v15
    v_cmp_gt_u32 s[50:51], v41, v15
    v_cmp_gt_u32 s[52:53], v42, v15
    v_cmp_gt_u32 s[54:55], v43, v15
    v_addc_co_u32 v14, s[56:57], 0, v14, s[48:49]
    v_addc_co_u32 v14, s[56:57], 0, v14, s[50:51]
    v_addc_co_u32 v14, s[56:57], 0, v14, s[52:53]
    v_addc_co_u32 v14, s[56:57], 0, v14, s[54:55]
    v_lshl_or_b32 v8, v13, 16, v12
    v_lshlrev_b32 v14, 3, v14
    ds_write_b64 v14, v[8:9] offset:128
    v_mov_b32 v10, 0
    v_mov_b32 v11, 0
    v_mov_b32 v12, 0
    v_mov_b32 v13, 0x7fff0000
    ds_write_b128 v9, v[10:13]
    ds_write_b64 v9, v[10:11] offset:16
    s_cmp_le_u32 s61, 0
    s_cbranch_scc1 K2_BRDONE
    ds_read_b32 v116, v116 offset:64
    s_cmp_le_u32 s61, 1
    s_cbranch_scc1 K2_BRDONE
    ds_read_b32 v117, v117 offset:64
    s_cmp_le_u32 s61, 2
    s_cbranch_scc1 K2_BRDONE
    ds_read_b32 v118, v118 offset:64
    s_cmp_le_u32 s61, 3
    s_cbranch_scc1 K2_BRDONE
    ds_read_b32 v119, v119 offset:64
    s_cmp_le_u32 s61, 4
    s_cbranch_scc1 K2_BRDONE
    ds_read_b32 v120, v120 offset:64
    s_cmp_le_u32 s61, 5
    s_cbranch_scc1 K2_BRDONE
    ds_read_b32 v121, v121 offset:64
    s_cmp_le_u32 s61, 6
    s_cbranch_scc1 K2_BRDONE
    ds_read_b32 v122, v122 offset:64
    s_cmp_le_u32 s61, 7
    s_cbranch_scc1 K2_BRDONE
    ds_read_b32 v123, v123 offset:64
    s_cmp_le_u32 s61, 8
    s_cbranch_scc1 K2_BRDONE
    ds_read_b32 v124, v124 offset:64
    s_cmp_le_u32 s61, 9
    s_cbranch_scc1 K2_BRDONE
    ds_read_b32 v125, v125 offset:64
    s_cmp_le_u32 s61, 10
    s_cbranch_scc1 K2_BRDONE
    ds_read_b32 v126, v126 offset:64
    s_cmp_le_u32 s61, 11
    s_cbranch_scc1 K2_BRDONE
    ds_read_b32 v127, v127 offset:64
K2_BRDONE:
    s_waitcnt lgkmcnt(0)
    s_cmp_le_u32 s61, 0
    s_cbranch_scc1 K2_WRDONE
    v_lshl_add_u32 v14, v46, 5, v116
    v_lshlrev_b32 v10, 16, v70
    v_and_b32 v10, 0xbfff0000, v10
    v_and_b32 v11, 0xbfff0000, v70
    v_lshlrev_b32 v12, 16, v71
    v_lshrrev_b32 v13, 18, v71
    v_mul_u32_u24 v13, 640, v13
    s_mov_b64 exec, s[62:63]
    ds_write_b128 v14, v[10:13]
    ds_write_b64 v14, v[68:69] offset:16
    s_mov_b64 exec, -1
    s_cmp_le_u32 s61, 1
    s_cbranch_scc1 K2_WRDONE
    v_lshl_add_u32 v14, v47, 5, v117
    v_lshlrev_b32 v10, 16, v74
    v_and_b32 v10, 0xbfff0000, v10
    v_and_b32 v11, 0xbfff0000, v74
    v_lshlrev_b32 v12, 16, v75
    v_lshrrev_b32 v13, 18, v75
    v_mul_u32_u24 v13, 640, v13
    s_mov_b64 exec, s[64:65]
    ds_write_b128 v14, v[10:13]
    ds_write_b64 v14, v[72:73] offset:16
    s_mov_b64 exec, -1
    s_cmp_le_u32 s61, 2
    s_cbranch_scc1 K2_WRDONE
    v_lshl_add_u32 v14, v48, 5, v118
    v_lshlrev_b32 v10, 16, v78
    v_and_b32 v10, 0xbfff0000, v10
    v_and_b32 v11, 0xbfff0000, v78
    v_lshlrev_b32 v12, 16, v79
    v_lshrrev_b32 v13, 18, v79
    v_mul_u32_u24 v13, 640, v13
    s_mov_b64 exec, s[66:67]
    ds_write_b128 v14, v[10:13]
    ds_write_b64 v14, v[76:77] offset:16
    s_mov_b64 exec, -1
    s_cmp_le_u32 s61, 3
    s_cbranch_scc1 K2_WRDONE
    v_lshl_add_u32 v14, v49, 5, v119
    v_lshlrev_b32 v10, 16, v82
    v_and_b32 v10, 0xbfff0000, v10
    v_and_b32 v11, 0xbfff0000, v82
    v_lshlrev_b32 v12, 16, v83
    v_lshrrev_b32 v13, 18, v83
    v_mul_u32_u24 v13, 640, v13
    s_mov_b64 exec, s[68:69]
    ds_write_b128 v14, v[10:13]
    ds_write_b64 v14, v[80:81] offset:16
    s_mov_b64 exec, -1
    s_cmp_le_u32 s61, 4
    s_cbranch_scc1 K2_WRDONE
    v_lshl_add_u32 v14, v50, 5, v120
    v_lshlrev_b32 v10, 16, v86
    v_and_b32 v10, 0xbfff0000, v10
    v_and_b32 v11, 0xbfff0000, v86
    v_lshlrev_b32 v12, 16, v87
    v_lshrrev_b32 v13, 18, v87
    v_mul_u32_u24 v13, 640, v13
    s_mov_b64 exec, s[70:71]
    ds_write_b128 v14, v[10:13]
    ds_write_b64 v14, v[84:85] offset:16
    s_mov_b64 exec, -1
    s_cmp_le_u32 s61, 5
    s_cbranch_scc1 K2_WRDONE
    v_lshl_add_u32 v14, v51, 5, v121
    v_lshlrev_b32 v10, 16, v90
    v_and_b32 v10, 0xbfff0000, v10
    v_and_b32 v11, 0xbfff0000, v90
    v_lshlrev_b32 v12, 16, v91
    v_lshrrev_b32 v13, 18, v91
    v_mul_u32_u24 v13, 640, v13
    s_mov_b64 exec, s[72:73]
    ds_write_b128 v14, v[10:13]
    ds_write_b64 v14, v[88:89] offset:16
    s_mov_b64 exec, -1
    s_cmp_le_u32 s61, 6
    s_cbranch_scc1 K2_WRDONE
    v_lshl_add_u32 v14, v52, 5, v122
    v_lshlrev_b32 v10, 16, v94
    v_and_b32 v10, 0xbfff0000, v10
    v_and_b32 v11, 0xbfff0000, v94
    v_lshlrev_b32 v12, 16, v95
    v_lshrrev_b32 v13, 18, v95
    v_mul_u32_u24 v13, 640, v13
    s_mov_b64 exec, s[74:75]
    ds_write_b128 v14, v[10:13]
    ds_write_b64 v14, v[92:93] offset:16
    s_mov_b64 exec, -1
    s_cmp_le_u32 s61, 7
    s_cbranch_scc1 K2_WRDONE
    v_lshl_add_u32 v14, v53, 5, v123
    v_lshlrev_b32 v10, 16, v98
    v_and_b32 v10, 0xbfff0000, v10
    v_and_b32 v11, 0xbfff0000, v98
    v_lshlrev_b32 v12, 16, v99
    v_lshrrev_b32 v13, 18, v99
    v_mul_u32_u24 v13, 640, v13
    s_mov_b64 exec, s[76:77]
    ds_write_b128 v14, v[10:13]
    ds_write_b64 v14, v[96:97] offset:16
    s_mov_b64 exec, -1
    s_cmp_le_u32 s61, 8
    s_cbranch_scc1 K2_WRDONE
    v_lshl_add_u32 v14, v54, 5, v124
    v_lshlrev_b32 v10, 16, v102
    v_and_b32 v10, 0xbfff0000, v10
    v_and_b32 v11, 0xbfff0000, v102
    v_lshlrev_b32 v12, 16, v103
    v_lshrrev_b32 v13, 18, v103
    v_mul_u32_u24 v13, 640, v13
    s_mov_b64 exec, s[78:79]
    ds_write_b128 v14, v[10:13]
    ds_write_b64 v14, v[100:101] offset:16
    s_mov_b64 exec, -1
    s_cmp_le_u32 s61, 9
    s_cbranch_scc1 K2_WRDONE
    v_lshl_add_u32 v14, v55, 5, v125
    v_lshlrev_b32 v10, 16, v106
    v_and_b32 v10, 0xbfff0000, v10
    v_and_b32 v11, 0xbfff0000, v106
    v_lshlrev_b32 v12, 16, v107
    v_lshrrev_b32 v13, 18, v107
    v_mul_u32_u24 v13, 640, v13
    s_mov_b64 exec, s[80:81]
    ds_write_b128 v14, v[10:13]
    ds_write_b64 v14, v[104:105] offset:16
    s_mov_b64 exec, -1
    s_cmp_le_u32 s61, 10
    s_cbranch_scc1 K2_WRDONE
    v_lshl_add_u32 v14, v56, 5, v126
    v_lshlrev_b32 v10, 16, v110
    v_and_b32 v10, 0xbfff0000, v10
    v_and_b32 v11, 0xbfff0000, v110
    v_lshlrev_b32 v12, 16, v111
    v_lshrrev_b32 v13, 18, v111
    v_mul_u32_u24 v13, 640, v13
    s_mov_b64 exec, s[82:83]
    ds_write_b128 v14, v[10:13]
    ds_write_b64 v14, v[108:109] offset:16
    s_mov_b64 exec, -1
    s_cmp_le_u32 s61, 11
    s_cbranch_scc1 K2_WRDONE
    v_lshl_add_u32 v14, v57, 5, v127
    v_lshlrev_b32 v10, 16, v114
    v_and_b32 v10, 0xbfff0000, v10
    v_and_b32 v11, 0xbfff0000, v114
    v_lshlrev_b32 v12, 16, v115
    v_lshrrev_b32 v13, 18, v115
    v_mul_u32_u24 v13, 640, v13
    s_mov_b64 exec, s[84:85]
    ds_write_b128 v14, v[10:13]
    ds_write_b64 v14, v[112:113] offset:16
    s_mov_b64 exec, -1
K2_WRDONE:
    v_lshrrev_b32 v7, 5, v0
    v_lshlrev_b32 v7, 3, v7
    s_mov_b32 s48, 0
    s_mov_b32 s49, 0
    v_mov_b32 v97, v3
    v_mov_b32 v127, v3
    s_mov_b32 s50, 0
    s_cmp_gt_i32 s49, 0
    s_cbranch_scc1 K2I0_GO
    s_cmp_ge_u32 s48, 4
    s_cbranch_scc1 K2I0_E
    ds_read_b64 v[10:11], v7 offset:128
    v_add_u32 v7, 16, v7
    s_add_u32 s48, s48, 1
    s_mov_b32 s50, 0x100
    s_waitcnt lgkmcnt(0)
    v_and_b32 v5, 0xffff, v10
    v_mov_b32 v6, v11
    v_lshrrev_b32 v10, 16, v10
    v_sub_u32 v12, v11, v5
    v_lshl_add_u32 v97, v10, 10, v3
    v_readfirstlane_b32 s49, v12
    buffer_load_dword v88, v97, s[28:31], 0 offen offset:0 sc1
    buffer_load_dword v89, v97, s[28:31], 0 offen offset:256 sc1
    buffer_load_dword v90, v97, s[28:31], 0 offen offset:512 sc1
    buffer_load_dword v91, v97, s[28:31], 0 offen offset:768 sc1
    s_lshr_b32 s49, s49, 5
K2I0_GO:
    v_add_u32 v96, v5, v4
    v_min_u32 v96, v96, v6
    v_mov_b32 v92, v5
    v_add_u32 v93, 32, v92
    v_min_u32 v93, v93, v6
    v_add_u32 v94, 32, v93
    v_min_u32 v94, v94, v6
    v_add_u32 v95, 32, v94
    v_min_u32 v95, v95, v6
    ds_read_b32 v10, v92 offset:12
    ds_read_b32 v11, v93 offset:12
    ds_read_b32 v12, v94 offset:12
    ds_read_b32 v13, v95 offset:12
    v_add_u32 v5, 32, v95
    v_min_u32 v5, v5, v6
    s_min_i32 s58, s49, 4
    s_max_i32 s58, s58, 0
    s_or_b32 s50, s50, s58
    s_or_b32 s50, s50, 0x400
    s_sub_i32 s49, s49, 4
    s_cmp_gt_i32 s49, 0
    s_cbranch_scc1 K2I0_NL
    s_or_b32 s50, s50, 0x200
K2I0_NL:
    s_waitcnt lgkmcnt(3)
    v_add_u32 v14, v10, v1
    v_add_u32 v15, v10, v2
    buffer_load_dwordx4 v[68:71], v14, s[16:19], 0 offen
    buffer_load_dword v84, v15, s[16:19], 0 offen offset:512
    s_waitcnt lgkmcnt(2)
    v_add_u32 v14, v11, v1
    v_add_u32 v15, v11, v2
    buffer_load_dwordx4 v[72:75], v14, s[16:19], 0 offen
    buffer_load_dword v85, v15, s[16:19], 0 offen offset:512
    s_waitcnt lgkmcnt(1)
    v_add_u32 v14, v12, v1
    v_add_u32 v15, v12, v2
    buffer_load_dwordx4 v[76:79], v14, s[16:19], 0 offen
    buffer_load_dword v86, v15, s[16:19], 0 offen offset:512
    s_waitcnt lgkmcnt(0)
    v_add_u32 v14, v13, v1
    v_add_u32 v15, v13, v2
    buffer_load_dwordx4 v[80:83], v14, s[16:19], 0 offen
    buffer_load_dword v87, v15, s[16:19], 0 offen offset:512
K2I0_E:
    s_mov_b32 s51, 0
    s_cmp_gt_i32 s49, 0
    s_cbranch_scc1 K2I1_GO
    s_cmp_ge_u32 s48, 4
    s_cbranch_scc1 K2I1_E
    ds_read_b64 v[10:11], v7 offset:128
    v_add_u32 v7, 16, v7
    s_add_u32 s48, s48, 1
    s_mov_b32 s51, 0x100
    s_waitcnt lgkmcnt(0)
    v_and_b32 v5, 0xffff, v10
    v_mov_b32 v6, v11
    v_lshrrev_b32 v10, 16, v10
    v_sub_u32 v12, v11, v5
    v_lshl_add_u32 v127, v10, 10, v3
    v_readfirstlane_b32 s49, v12
    buffer_load_dword v118, v127, s[28:31], 0 offen offset:0 sc1
    buffer_load_dword v119, v127, s[28:31], 0 offen offset:256 sc1
    buffer_load_dword v120, v127, s[28:31], 0 offen offset:512 sc1
    buffer_load_dword v121, v127, s[28:31], 0 offen offset:768 sc1
    s_lshr_b32 s49, s49, 5
K2I1_GO:
    v_add_u32 v126, v5, v4
    v_min_u32 v126, v126, v6
    v_mov_b32 v122, v5
    v_add_u32 v123, 32, v122
    v_min_u32 v123, v123, v6
    v_add_u32 v124, 32, v123
    v_min_u32 v124, v124, v6
    v_add_u32 v125, 32, v124
    v_min_u32 v125, v125, v6
    ds_read_b32 v10, v122 offset:12
    ds_read_b32 v11, v123 offset:12
    ds_read_b32 v12, v124 offset:12
    ds_read_b32 v13, v125 offset:12
    v_add_u32 v5, 32, v125
    v_min_u32 v5, v5, v6
    s_min_i32 s58, s49, 4
    s_max_i32 s58, s58, 0
    s_or_b32 s51, s51, s58
    s_or_b32 s51, s51, 0x400
    s_sub_i32 s49, s49, 4
    s_cmp_gt_i32 s49, 0
    s_cbranch_scc1 K2I1_NL
    s_or_b32 s51, s51, 0x200
K2I1_NL:
    s_waitcnt lgkmcnt(3)
    v_add_u32 v14, v10, v1
    v_add_u32 v15, v10, v2
    buffer_load_dwordx4 v[98:101], v14, s[16:19], 0 offen
    buffer_load_dword v114, v15, s[16:19], 0 offen offset:512
    s_waitcnt lgkmcnt(2)
    v_add_u32 v14, v11, v1
    v_add_u32 v15, v11, v2
    buffer_load_dwordx4 v[102:105], v14, s[16:19], 0 offen
    buffer_load_dword v115, v15, s[16:19], 0 offen offset:512
    s_waitcnt lgkmcnt(1)
    v_add_u32 v14, v12, v1
    v_add_u32 v15, v12, v2
    buffer_load_dwordx4 v[106:109], v14, s[16:19], 0 offen
    buffer_load_dword v116, v15, s[16:19], 0 offen offset:512
    s_waitcnt lgkmcnt(0)
    v_add_u32 v14, v13, v1
    v_add_u32 v15, v13, v2
    buffer_load_dwordx4 v[110:113], v14, s[16:19], 0 offen
    buffer_load_dword v117, v15, s[16:19], 0 offen offset:512
K2I1_E:
K2_LOOP:
    s_cmp_eq_u32 s50, 0
    s_cbranch_scc1 K2_ROUNDEND
    ds_read_b64 v[8:9], v96 offset:16
    ds_read_b96 v[16:18], v92
    ds_read_b96 v[20:22], v93
    s_and_b32 s58, s50, 7
    s_waitcnt lgkmcnt(2)
    v_mfma_f32_4x4x4_16b_bf16 v[64:67], v[8:9], v[34:35], 0
    v_mfma_f32_4x4x4_16b_bf16 v[60:63], v[8:9], v[32:33], 0
    v_mfma_f32_4x4x4_16b_bf16 v[48:51], v[8:9], v[26:27], 0
    v_mfma_f32_4x4x4_16b_bf16 v[44:47], v[8:9], v[24:25], 0
    v_mfma_f32_4x4x4_16b_bf16 v[56:59], v[8:9], v[30:31], 0
    v_mfma_f32_4x4x4_16b_bf16 v[52:55], v[8:9], v[28:29], 0
    s_cmp_eq_u32 s51, 0
    s_cbranch_scc0 K2C0_W8
    s_waitcnt vmcnt(0)
K2C0_W8:
    s_waitcnt vmcnt(8)
    s_bitcmp1_b32 s50, 8
    s_cbranch_scc0 K2C0_NF
    v_lshlrev_b32 v36, 16, v88
    v_and_b32 v37, 0xffff0000, v88
    v_lshlrev_b32 v38, 16, v89
    v_and_b32 v39, 0xffff0000, v89
    v_lshlrev_b32 v40, 16, v90
    v_and_b32 v41, 0xffff0000, v90
    v_lshlrev_b32 v42, 16, v91
    v_and_b32 v43, 0xffff0000, v91
    v_mov_b32 v0, v97
K2C0_NF:
    s_cmp_le_u32 s58, 0
    s_cbranch_scc1 K2C0_SD
    s_waitcnt lgkmcnt(1)
    v_and_b32 v10, 0xffff0000, v84
    v_and_b32 v11, 0xffff0000, v68
    v_and_b32 v12, 0xffff0000, v69
    v_and_b32 v13, 0xffff0000, v70
    v_and_b32 v14, 0xffff0000, v71
    v_mul_f32 v10, v10, v64
    v_fmac_f32 v37, v11, v48
    v_fmac_f32 v39, v12, v56
    v_fmac_f32 v41, v13, v56
    v_fmac_f32 v43, v14, v56
    v_fmac_f32 v39, v10, v16
    v_fmac_f32 v41, v10, v17
    v_fmac_f32 v43, v10, v18
    v_lshlrev_b32 v10, 16, v84
    v_lshlrev_b32 v11, 16, v68
    v_lshlrev_b32 v12, 16, v69
    v_lshlrev_b32 v13, 16, v70
    v_lshlrev_b32 v14, 16, v71
    v_mul_f32 v10, v10, v60
    v_fmac_f32 v36, v11, v44
    v_fmac_f32 v38, v12, v52
    v_fmac_f32 v40, v13, v52
    v_fmac_f32 v42, v14, v52
    v_fmac_f32 v38, v10, v16
    v_fmac_f32 v40, v10, v17
    v_fmac_f32 v42, v10, v18
    ds_read_b96 v[16:18], v94
    s_cmp_le_u32 s58, 1
    s_cbranch_scc1 K2C0_SD
    s_waitcnt lgkmcnt(1)
    v_and_b32 v10, 0xffff0000, v85
    v_and_b32 v11, 0xffff0000, v72
    v_and_b32 v12, 0xffff0000, v73
    v_and_b32 v13, 0xffff0000, v74
    v_and_b32 v14, 0xffff0000, v75
    v_mul_f32 v10, v10, v65
    v_fmac_f32 v37, v11, v49
    v_fmac_f32 v39, v12, v57
    v_fmac_f32 v41, v13, v57
    v_fmac_f32 v43, v14, v57
    v_fmac_f32 v39, v10, v20
    v_fmac_f32 v41, v10, v21
    v_fmac_f32 v43, v10, v22
    v_lshlrev_b32 v10, 16, v85
    v_lshlrev_b32 v11, 16, v72
    v_lshlrev_b32 v12, 16, v73
    v_lshlrev_b32 v13, 16, v74
    v_lshlrev_b32 v14, 16, v75
    v_mul_f32 v10, v10, v61
    v_fmac_f32 v36, v11, v45
    v_fmac_f32 v38, v12, v53
    v_fmac_f32 v40, v13, v53
    v_fmac_f32 v42, v14, v53
    v_fmac_f32 v38, v10, v20
    v_fmac_f32 v40, v10, v21
    v_fmac_f32 v42, v10, v22
    ds_read_b96 v[20:22], v95
    s_cmp_le_u32 s58, 2
    s_cbranch_scc1 K2C0_SD
    s_waitcnt lgkmcnt(1)
    v_and_b32 v10, 0xffff0000, v86
    v_and_b32 v11, 0xffff0000, v76
    v_and_b32 v12, 0xffff0000, v77
    v_and_b32 v13, 0xffff0000, v78
    v_and_b32 v14, 0xffff0000, v79
    v_mul_f32 v10, v10, v66
    v_fmac_f32 v37, v11, v50
    v_fmac_f32 v39, v12, v58
    v_fmac_f32 v41, v13, v58
    v_fmac_f32 v43, v14, v58
    v_fmac_f32 v39, v10, v16
    v_fmac_f32 v41, v10, v17
    v_fmac_f32 v43, v10, v18
    v_lshlrev_b32 v10, 16, v86
    v_lshlrev_b32 v11, 16, v76
    v_lshlrev_b32 v12, 16, v77
    v_lshlrev_b32 v13, 16, v78
    v_lshlrev_b32 v14, 16, v79
    v_mul_f32 v10, v10, v62
    v_fmac_f32 v36, v11, v46
    v_fmac_f32 v38, v12, v54
    v_fmac_f32 v40, v13, v54
    v_fmac_f32 v42, v14, v54
    v_fmac_f32 v38, v10, v16
    v_fmac_f32 v40, v10, v17
    v_fmac_f32 v42, v10, v18
    s_cmp_le_u32 s58, 3
    s_cbranch_scc1 K2C0_SD
    s_waitcnt lgkmcnt(0)
    v_and_b32 v10, 0xffff0000, v87
    v_and_b32 v11, 0xffff0000, v80
    v_and_b32 v12, 0xffff0000, v81
    v_and_b32 v13, 0xffff0000, v82
    v_and_b32 v14, 0xffff0000, v83
    v_mul_f32 v10, v10, v67
    v_fmac_f32 v37, v11, v51
    v_fmac_f32 v39, v12, v59
    v_fmac_f32 v41, v13, v59
    v_fmac_f32 v43, v14, v59
    v_fmac_f32 v39, v10, v20
    v_fmac_f32 v41, v10, v21
    v_fmac_f32 v43, v10, v22
    v_lshlrev_b32 v10, 16, v87
    v_lshlrev_b32 v11, 16, v80
    v_lshlrev_b32 v12, 16, v81
    v_lshlrev_b32 v13, 16, v82
    v_lshlrev_b32 v14, 16, v83
    v_mul_f32 v10, v10, v63
    v_fmac_f32 v36, v11, v47
    v_fmac_f32 v38, v12, v55
    v_fmac_f32 v40, v13, v55
    v_fmac_f32 v42, v14, v55
    v_fmac_f32 v38, v10, v20
    v_fmac_f32 v40, v10, v21
    v_fmac_f32 v42, v10, v22
K2C0_SD:
    s_bitcmp1_b32 s50, 9
    s_cbranch_scc0 K2C0_NE
    v_cvt_pk_bf16_f32 v10, v36, v37
    buffer_store_dword v10, v0, s[32:35], 0 offen offset:0 nt
    v_cvt_pk_bf16_f32 v11, v38, v39
    buffer_store_dword v11, v0, s[32:35], 0 offen offset:256 nt
    v_cvt_pk_bf16_f32 v12, v40, v41
    buffer_store_dword v12, v0, s[32:35], 0 offen offset:512 nt
    v_cvt_pk_bf16_f32 v13, v42, v43
    buffer_store_dword v13, v0, s[32:35], 0 offen offset:768 nt
K2C0_NE:
    s_waitcnt lgkmcnt(0)
    s_mov_b32 s50, 0
    s_cmp_gt_i32 s49, 0
    s_cbranch_scc1 K2I2_GO
    s_cmp_ge_u32 s48, 4
    s_cbranch_scc1 K2I2_E
    ds_read_b64 v[10:11], v7 offset:128
    v_add_u32 v7, 16, v7
    s_add_u32 s48, s48, 1
    s_mov_b32 s50, 0x100
    s_waitcnt lgkmcnt(0)
    v_and_b32 v5, 0xffff, v10
    v_mov_b32 v6, v11
    v_lshrrev_b32 v10, 16, v10
    v_sub_u32 v12, v11, v5
    v_lshl_add_u32 v97, v10, 10, v3
    v_readfirstlane_b32 s49, v12
    buffer_load_dword v88, v97, s[28:31], 0 offen offset:0 sc1
    buffer_load_dword v89, v97, s[28:31], 0 offen offset:256 sc1
    buffer_load_dword v90, v97, s[28:31], 0 offen offset:512 sc1
    buffer_load_dword v91, v97, s[28:31], 0 offen offset:768 sc1
    s_lshr_b32 s49, s49, 5
K2I2_GO:
    v_add_u32 v96, v5, v4
    v_min_u32 v96, v96, v6
    v_mov_b32 v92, v5
    v_add_u32 v93, 32, v92
    v_min_u32 v93, v93, v6
    v_add_u32 v94, 32, v93
    v_min_u32 v94, v94, v6
    v_add_u32 v95, 32, v94
    v_min_u32 v95, v95, v6
    ds_read_b32 v10, v92 offset:12
    ds_read_b32 v11, v93 offset:12
    ds_read_b32 v12, v94 offset:12
    ds_read_b32 v13, v95 offset:12
    v_add_u32 v5, 32, v95
    v_min_u32 v5, v5, v6
    s_min_i32 s58, s49, 4
    s_max_i32 s58, s58, 0
    s_or_b32 s50, s50, s58
    s_or_b32 s50, s50, 0x400
    s_sub_i32 s49, s49, 4
    s_cmp_gt_i32 s49, 0
    s_cbranch_scc1 K2I2_NL
    s_or_b32 s50, s50, 0x200
K2I2_NL:
    s_waitcnt lgkmcnt(3)
    v_add_u32 v14, v10, v1
    v_add_u32 v15, v10, v2
    buffer_load_dwordx4 v[68:71], v14, s[16:19], 0 offen
    buffer_load_dword v84, v15, s[16:19], 0 offen offset:512
    s_waitcnt lgkmcnt(2)
    v_add_u32 v14, v11, v1
    v_add_u32 v15, v11, v2
    buffer_load_dwordx4 v[72:75], v14, s[16:19], 0 offen
    buffer_load_dword v85, v15, s[16:19], 0 offen offset:512
    s_waitcnt lgkmcnt(1)
    v_add_u32 v14, v12, v1
    v_add_u32 v15, v12, v2
    buffer_load_dwordx4 v[76:79], v14, s[16:19], 0 offen
    buffer_load_dword v86, v15, s[16:19], 0 offen offset:512
    s_waitcnt lgkmcnt(0)
    v_add_u32 v14, v13, v1
    v_add_u32 v15, v13, v2
    buffer_load_dwordx4 v[80:83], v14, s[16:19], 0 offen
    buffer_load_dword v87, v15, s[16:19], 0 offen offset:512
K2I2_E:
    s_cmp_eq_u32 s51, 0
    s_cbranch_scc1 K2_ROUNDEND
    ds_read_b64 v[8:9], v126 offset:16
    ds_read_b96 v[16:18], v122
    ds_read_b96 v[20:22], v123
    s_and_b32 s58, s51, 7
    s_waitcnt lgkmcnt(2)
    v_mfma_f32_4x4x4_16b_bf16 v[64:67], v[8:9], v[34:35], 0
    v_mfma_f32_4x4x4_16b_bf16 v[60:63], v[8:9], v[32:33], 0
    v_mfma_f32_4x4x4_16b_bf16 v[48:51], v[8:9], v[26:27], 0
    v_mfma_f32_4x4x4_16b_bf16 v[44:47], v[8:9], v[24:25], 0
    v_mfma_f32_4x4x4_16b_bf16 v[56:59], v[8:9], v[30:31], 0
    v_mfma_f32_4x4x4_16b_bf16 v[52:55], v[8:9], v[28:29], 0
    s_cmp_eq_u32 s50, 0
    s_cbranch_scc0 K2C1_W8
    s_waitcnt vmcnt(0)
K2C1_W8:
    s_waitcnt vmcnt(8)
    s_bitcmp1_b32 s51, 8
    s_cbranch_scc0 K2C1_NF
    v_lshlrev_b32 v36, 16, v118
    v_and_b32 v37, 0xffff0000, v118
    v_lshlrev_b32 v38, 16, v119
    v_and_b32 v39, 0xffff0000, v119
    v_lshlrev_b32 v40, 16, v120
    v_and_b32 v41, 0xffff0000, v120
    v_lshlrev_b32 v42, 16, v121
    v_and_b32 v43, 0xffff0000, v121
    v_mov_b32 v0, v127
K2C1_NF:
    s_cmp_le_u32 s58, 0
    s_cbranch_scc1 K2C1_SD
    s_waitcnt lgkmcnt(1)
    v_and_b32 v10, 0xffff0000, v114
    v_and_b32 v11, 0xffff0000, v98
    v_and_b32 v12, 0xffff0000, v99
    v_and_b32 v13, 0xffff0000, v100
    v_and_b32 v14, 0xffff0000, v101
    v_mul_f32 v10, v10, v64
    v_fmac_f32 v37, v11, v48
    v_fmac_f32 v39, v12, v56
    v_fmac_f32 v41, v13, v56
    v_fmac_f32 v43, v14, v56
    v_fmac_f32 v39, v10, v16
    v_fmac_f32 v41, v10, v17
    v_fmac_f32 v43, v10, v18
    v_lshlrev_b32 v10, 16, v114
    v_lshlrev_b32 v11, 16, v98
    v_lshlrev_b32 v12, 16, v99
    v_lshlrev_b32 v13, 16, v100
    v_lshlrev_b32 v14, 16, v101
    v_mul_f32 v10, v10, v60
    v_fmac_f32 v36, v11, v44
    v_fmac_f32 v38, v12, v52
    v_fmac_f32 v40, v13, v52
    v_fmac_f32 v42, v14, v52
    v_fmac_f32 v38, v10, v16
    v_fmac_f32 v40, v10, v17
    v_fmac_f32 v42, v10, v18
    ds_read_b96 v[16:18], v124
    s_cmp_le_u32 s58, 1
    s_cbranch_scc1 K2C1_SD
    s_waitcnt lgkmcnt(1)
    v_and_b32 v10, 0xffff0000, v115
    v_and_b32 v11, 0xffff0000, v102
    v_and_b32 v12, 0xffff0000, v103
    v_and_b32 v13, 0xffff0000, v104
    v_and_b32 v14, 0xffff0000, v105
    v_mul_f32 v10, v10, v65
    v_fmac_f32 v37, v11, v49
    v_fmac_f32 v39, v12, v57
    v_fmac_f32 v41, v13, v57
    v_fmac_f32 v43, v14, v57
    v_fmac_f32 v39, v10, v20
    v_fmac_f32 v41, v10, v21
    v_fmac_f32 v43, v10, v22
    v_lshlrev_b32 v10, 16, v115
    v_lshlrev_b32 v11, 16, v102
    v_lshlrev_b32 v12, 16, v103
    v_lshlrev_b32 v13, 16, v104
    v_lshlrev_b32 v14, 16, v105
    v_mul_f32 v10, v10, v61
    v_fmac_f32 v36, v11, v45
    v_fmac_f32 v38, v12, v53
    v_fmac_f32 v40, v13, v53
    v_fmac_f32 v42, v14, v53
    v_fmac_f32 v38, v10, v20
    v_fmac_f32 v40, v10, v21
    v_fmac_f32 v42, v10, v22
    ds_read_b96 v[20:22], v125
    s_cmp_le_u32 s58, 2
    s_cbranch_scc1 K2C1_SD
    s_waitcnt lgkmcnt(1)
    v_and_b32 v10, 0xffff0000, v116
    v_and_b32 v11, 0xffff0000, v106
    v_and_b32 v12, 0xffff0000, v107
    v_and_b32 v13, 0xffff0000, v108
    v_and_b32 v14, 0xffff0000, v109
    v_mul_f32 v10, v10, v66
    v_fmac_f32 v37, v11, v50
    v_fmac_f32 v39, v12, v58
    v_fmac_f32 v41, v13, v58
    v_fmac_f32 v43, v14, v58
    v_fmac_f32 v39, v10, v16
    v_fmac_f32 v41, v10, v17
    v_fmac_f32 v43, v10, v18
    v_lshlrev_b32 v10, 16, v116
    v_lshlrev_b32 v11, 16, v106
    v_lshlrev_b32 v12, 16, v107
    v_lshlrev_b32 v13, 16, v108
    v_lshlrev_b32 v14, 16, v109
    v_mul_f32 v10, v10, v62
    v_fmac_f32 v36, v11, v46
    v_fmac_f32 v38, v12, v54
    v_fmac_f32 v40, v13, v54
    v_fmac_f32 v42, v14, v54
    v_fmac_f32 v38, v10, v16
    v_fmac_f32 v40, v10, v17
    v_fmac_f32 v42, v10, v18
    s_cmp_le_u32 s58, 3
    s_cbranch_scc1 K2C1_SD
    s_waitcnt lgkmcnt(0)
    v_and_b32 v10, 0xffff0000, v117
    v_and_b32 v11, 0xffff0000, v110
    v_and_b32 v12, 0xffff0000, v111
    v_and_b32 v13, 0xffff0000, v112
    v_and_b32 v14, 0xffff0000, v113
    v_mul_f32 v10, v10, v67
    v_fmac_f32 v37, v11, v51
    v_fmac_f32 v39, v12, v59
    v_fmac_f32 v41, v13, v59
    v_fmac_f32 v43, v14, v59
    v_fmac_f32 v39, v10, v20
    v_fmac_f32 v41, v10, v21
    v_fmac_f32 v43, v10, v22
    v_lshlrev_b32 v10, 16, v117
    v_lshlrev_b32 v11, 16, v110
    v_lshlrev_b32 v12, 16, v111
    v_lshlrev_b32 v13, 16, v112
    v_lshlrev_b32 v14, 16, v113
    v_mul_f32 v10, v10, v63
    v_fmac_f32 v36, v11, v47
    v_fmac_f32 v38, v12, v55
    v_fmac_f32 v40, v13, v55
    v_fmac_f32 v42, v14, v55
    v_fmac_f32 v38, v10, v20
    v_fmac_f32 v40, v10, v21
    v_fmac_f32 v42, v10, v22
K2C1_SD:
    s_bitcmp1_b32 s51, 9
    s_cbranch_scc0 K2C1_NE
    v_cvt_pk_bf16_f32 v10, v36, v37
    buffer_store_dword v10, v0, s[32:35], 0 offen offset:0 nt
    v_cvt_pk_bf16_f32 v11, v38, v39
    buffer_store_dword v11, v0, s[32:35], 0 offen offset:256 nt
    v_cvt_pk_bf16_f32 v12, v40, v41
    buffer_store_dword v12, v0, s[32:35], 0 offen offset:512 nt
    v_cvt_pk_bf16_f32 v13, v42, v43
    buffer_store_dword v13, v0, s[32:35], 0 offen offset:768 nt
K2C1_NE:
    s_waitcnt lgkmcnt(0)
    s_mov_b32 s51, 0
    s_cmp_gt_i32 s49, 0
    s_cbranch_scc1 K2I3_GO
    s_cmp_ge_u32 s48, 4
    s_cbranch_scc1 K2I3_E
    ds_read_b64 v[10:11], v7 offset:128
    v_add_u32 v7, 16, v7
    s_add_u32 s48, s48, 1
    s_mov_b32 s51, 0x100
    s_waitcnt lgkmcnt(0)
    v_and_b32 v5, 0xffff, v10
    v_mov_b32 v6, v11
    v_lshrrev_b32 v10, 16, v10
    v_sub_u32 v12, v11, v5
    v_lshl_add_u32 v127, v10, 10, v3
    v_readfirstlane_b32 s49, v12
    buffer_load_dword v118, v127, s[28:31], 0 offen offset:0 sc1
    buffer_load_dword v119, v127, s[28:31], 0 offen offset:256 sc1
    buffer_load_dword v120, v127, s[28:31], 0 offen offset:512 sc1
    buffer_load_dword v121, v127, s[28:31], 0 offen offset:768 sc1
    s_lshr_b32 s49, s49, 5
K2I3_GO:
    v_add_u32 v126, v5, v4
    v_min_u32 v126, v126, v6
    v_mov_b32 v122, v5
    v_add_u32 v123, 32, v122
    v_min_u32 v123, v123, v6
    v_add_u32 v124, 32, v123
    v_min_u32 v124, v124, v6
    v_add_u32 v125, 32, v124
    v_min_u32 v125, v125, v6
    ds_read_b32 v10, v122 offset:12
    ds_read_b32 v11, v123 offset:12
    ds_read_b32 v12, v124 offset:12
    ds_read_b32 v13, v125 offset:12
    v_add_u32 v5, 32, v125
    v_min_u32 v5, v5, v6
    s_min_i32 s58, s49, 4
    s_max_i32 s58, s58, 0
    s_or_b32 s51, s51, s58
    s_or_b32 s51, s51, 0x400
    s_sub_i32 s49, s49, 4
    s_cmp_gt_i32 s49, 0
    s_cbranch_scc1 K2I3_NL
    s_or_b32 s51, s51, 0x200
K2I3_NL:
    s_waitcnt lgkmcnt(3)
    v_add_u32 v14, v10, v1
    v_add_u32 v15, v10, v2
    buffer_load_dwordx4 v[98:101], v14, s[16:19], 0 offen
    buffer_load_dword v114, v15, s[16:19], 0 offen offset:512
    s_waitcnt lgkmcnt(2)
    v_add_u32 v14, v11, v1
    v_add_u32 v15, v11, v2
    buffer_load_dwordx4 v[102:105], v14, s[16:19], 0 offen
    buffer_load_dword v115, v15, s[16:19], 0 offen offset:512
    s_waitcnt lgkmcnt(1)
    v_add_u32 v14, v12, v1
    v_add_u32 v15, v12, v2
    buffer_load_dwordx4 v[106:109], v14, s[16:19], 0 offen
    buffer_load_dword v116, v15, s[16:19], 0 offen offset:512
    s_waitcnt lgkmcnt(0)
    v_add_u32 v14, v13, v1
    v_add_u32 v15, v13, v2
    buffer_load_dwordx4 v[110:113], v14, s[16:19], 0 offen
    buffer_load_dword v117, v15, s[16:19], 0 offen offset:512
K2I3_E:
    s_branch K2_LOOP
K2_ROUNDEND:
    s_cmp_eq_u32 s43, 0
    s_cbranch_scc1 K2_FIN
    s_waitcnt vmcnt(0) lgkmcnt(0)
    s_mov_b32 s28, s32
    s_mov_b32 s29, s33
    v_mbcnt_lo_u32_b32 v0, -1, 0
    v_mbcnt_hi_u32_b32 v0, -1, v0
    v_lshlrev_b32 v13, 4, v0
    buffer_load_dwordx2 v[8:9], v13, s[24:27], s40 offen
    s_waitcnt vmcnt(0)
    s_branch K2_ROUND
K2_FIN:
K2_END:
    s_endpgm
.section .rodata,"a"
.p2align 6
.amdhsa_kernel painn_prep_kernel
      .amdhsa_next_free_vgpr 256
      .amdhsa_next_free_sgpr 96
      .amdhsa_accum_offset 256
      .amdhsa_group_segment_fixed_size 0
      .amdhsa_kernarg_size 88
      .amdhsa_user_sgpr_count 2
      .amdhsa_user_sgpr_kernarg_segment_ptr 1
      .amdhsa_system_sgpr_workgroup_id_x 1
      .amdhsa_float_denorm_mode_32 3
.end_amdhsa_kernel
.p2align 6
.amdhsa_kernel painn_main_kernel
      .amdhsa_next_free_vgpr 128
      .amdhsa_next_free_sgpr 96
      .amdhsa_accum_offset 128
      .amdhsa_group_segment_fixed_size 0
      .amdhsa_kernarg_size 88
      .amdhsa_user_sgpr_count 2
      .amdhsa_user_sgpr_kernarg_segment_ptr 1
      .amdhsa_system_sgpr_workgroup_id_x 1
      .amdhsa_float_denorm_mode_32 3
.end_amdhsa_kernel
```
